```python
import torch

def _softmax(x, axis=-1):
    return torch.softmax(x, dim=axis)
def _gelu(x):
    return torch.nn.functional.gelu(x, approximate="tanh")
def _silu(x):
    return torch.nn.functional.silu(x)
def _sigmoid(x):
    return torch.sigmoid(x)
def _layernorm(x, axis=-1, eps=1e-5):
    m = x.mean(dim=axis, keepdim=True)
    v = x.var(dim=axis, keepdim=True, unbiased=False)
    return (x - m) / torch.sqrt(v + eps)
def _scatter_add(tgt, idx, src, axis=0):
    return tgt.clone().index_add_(axis, idx, src)
def _segment_sum(src, seg, n):
    out = torch.zeros((n,) + src.shape[1:], dtype=src.dtype)
    return out.index_add_(0, seg, src)
def _pad(x, pw):
    flat = tuple(v for pair in reversed(pw) for v in pair)
    return torch.nn.functional.pad(x, flat)

kernel_name = 'standalone__gqa_block_cached__near_ridge'

def setup_inputs():

    _w = (lambda a: (lambda t: t.to(torch.bfloat16) if t.is_floating_point() else t)(torch.as_tensor(a)))
    B, Sq, D = 8, 32, 512
    Hq, Hkv, Sk, Dh = 32, 8, 2048, 128
    assert Hq % Hkv == 0, (Hq, Hkv)
    return {
        "x": _w((lambda *s: torch.randn(*s, dtype=torch.bfloat16) * 0.8)(B, Sq, D)),
        "k_cache": _w((lambda *s: torch.randn(*s, dtype=torch.bfloat16) * 0.8)(B, Hkv, Sk, Dh)),
        "v_cache": _w((lambda *s: torch.randn(*s, dtype=torch.bfloat16) * 0.05)(B, Hkv, Sk, Dh)),
        "wq": _w((lambda *s: torch.randn(*s, dtype=torch.bfloat16) * 0.8)(D, Hq * Dh) * (D ** -0.5)),
        "wo": _w((lambda *s: torch.randn(*s, dtype=torch.bfloat16) * 0.05)(Hq * Dh, D) * ((Hq * Dh) ** -0.5)),
    }

def reference(x, k_cache, v_cache, wq, wo):
    B, Sq, D = x.shape
    Hq, Dh = 32, 128
    Hkv = k_cache.shape[1]
    rep = Hq // Hkv
    q = (lambda x, *d: x.permute(*d))((x @ wq).reshape(B, Sq, Hq, Dh), 0, 2, 1, 3)
    k = (lambda x, n, axis: torch.repeat_interleave(x, n, dim=axis))(k_cache, rep, axis=1)
    v = (lambda x, n, axis: torch.repeat_interleave(x, n, dim=axis))(v_cache, rep, axis=1)
    scores = torch.einsum("bhqd,bhkd->bhqk", q, k) * (Dh ** -0.5)
    p = _softmax(scores, axis=-1)
    o = torch.einsum("bhqk,bhkd->bhqd", p, v)
    return (lambda x, *d: x.permute(*d))(o, 0, 2, 1, 3).reshape(B, Sq, Hq * Dh) @ wo
```

```asm
; @launch grid=(256,1,1) block=(512,1,1) lds=163840
.amdgcn_target "amdgcn-amd-amdhsa--gfx950"
.text
.globl standalone__gqa_block_cached__near_ridge_kernel
.p2align 8
.type standalone__gqa_block_cached__near_ridge_kernel,@function
standalone__gqa_block_cached__near_ridge_kernel:
    s_cmp_ge_u32 s2, 256
    s_cbranch_scc1 L_end
    s_load_dwordx16 s[4:19], s[0:1], 0
    s_mov_b32 s70, s2
    v_and_b32 v1, 63, v0
    v_lshrrev_b32 v23, 6, v0
    v_lshlrev_b32 v2, 4, v1
    v_readfirstlane_b32 s48, v23
    s_and_b32 s49, s2, 7
    s_lshr_b32 s58, s2, 3
    s_lshr_b32 s50, s58, 2
    s_and_b32 s51, s58, 3
    s_lshr_b32 s52, s50, 1
    s_lshr_b32 s53, s48, 1
    s_and_b32 s54, s48, 1
    s_lshl_b32 s100, s48, 11
    v_lshrrev_b32 v24, 4, v1
    v_and_b32 v25, 15, v1
    s_lshl_b32 s58, s54, 3
    v_add_u32 v26, s58, v24
    v_lshlrev_b32 v27, 8, v24
    v_add_u32 v27, s100, v27
    v_xor_b32 v3, v26, v25
    v_lshlrev_b32 v3, 4, v3
    v_lshlrev_b32 v244, 2, v27
    v_add_u32 v244, v244, v3
    v_add_u32 v3, v3, v27
    v_xor_b32 v4, v26, v25
    v_xor_b32 v4, 4, v4
    v_lshlrev_b32 v4, 4, v4
    v_lshlrev_b32 v245, 2, v27
    v_add_u32 v245, v245, v4
    v_add_u32 v245, 3072, v245
    v_add_u32 v4, v4, v27
    v_lshrrev_b32 v240, 4, v1
    v_and_b32 v240, 1, v240
    v_lshlrev_b32 v240, 1, v240
    v_and_b32 v241, 7, v1
    v_xor_b32 v240, v240, v241
    v_lshlrev_b32 v240, 4, v240
    v_lshrrev_b32 v246, 3, v1
    v_lshlrev_b32 v246, 13, v246
    v_add_u32 v246, v246, v240
    v_xor_b32 v247, 64, v246
    s_lshl_b32 s58, s50, 3
    s_add_u32 s58, s58, s49
    s_lshl_b32 s58, s58, 19
    s_lshl_b32 s59, s51, 17
    s_add_u32 s58, s58, s59
    s_lshl_b32 s62, s52, 16
    s_and_b32 s63, s50, 1
    s_lshl_b32 s63, s63, 2
    s_add_u32 s63, s63, s51
    s_lshl_b32 s63, s63, 7
    s_lshl_b32 s64, s49, 10
    s_add_u32 s63, s63, s64
    s_lshl_b32 s64, s48, 17
    s_add_u32 s63, s63, s64
    s_waitcnt lgkmcnt(0)
    s_add_u32 s20, s6, s58
    s_addc_u32 s21, s7, 0
    s_mov_b32 s22, 0x20000
    s_mov_b32 s23, 0x00020000
    s_mov_b32 s28, s4
    s_mov_b32 s29, s5
    s_mov_b32 s30, 0x40000
    s_mov_b32 s31, 0x00020000
    s_mov_b32 s32, s10
    s_mov_b32 s33, s11
    s_mov_b32 s34, 0x400000
    s_mov_b32 s35, 0x00020000
    s_getreg_b32 s3, hwreg(HW_REG_XCC_ID, 0, 4)
    s_add_u32 m0, s100, 16384
    s_add_u32 s61, s63, 0
    buffer_load_dwordx4 v246, s[32:35], s61 offen lds
    s_add_u32 m0, s100, 17408
    s_add_u32 s61, s63, 65536
    buffer_load_dwordx4 v247, s[32:35], s61 offen lds
    s_add_u32 m0, s100, 0
    s_add_u32 s61, s62, 0
    buffer_load_dwordx4 v244, s[28:31], s61 offen lds
    s_add_u32 m0, s100, 0
    s_add_u32 s61, s62, 0
    buffer_load_dwordx4 v245, s[28:31], s61 offen offset:1024 lds
    s_add_u32 m0, s100, 49152
    s_add_u32 s61, s63, 1048576
    buffer_load_dwordx4 v246, s[32:35], s61 offen lds
    s_add_u32 m0, s100, 50176
    s_add_u32 s61, s63, 1114112
    buffer_load_dwordx4 v247, s[32:35], s61 offen lds
    s_lshl_b32 s60, s52, 7
    s_load_dword s55, s[18:19], s60
    s_add_u32 s24, s8, s58
    s_addc_u32 s25, s9, 0
    s_mov_b32 s26, 0x20000
    s_mov_b32 s27, 0x00020000
    s_lshl_b32 s58, s49, 19
    s_lshl_b32 s59, s51, 8
    s_add_u32 s58, s58, s59
    s_add_u32 s36, s12, s58
    s_addc_u32 s37, s13, 0
    s_mov_b32 s38, 0x7fd00
    s_mov_b32 s39, 0x00020000
    s_mov_b32 s40, s18
    s_mov_b32 s41, s19
    s_mov_b32 s42, 0x2000000
    s_mov_b32 s43, 0x00020000
    s_mov_b32 s44, s14
    s_mov_b32 s45, s15
    s_mov_b32 s46, 0x40000
    s_mov_b32 s47, 0x00020000
    s_mov_b32 s56, 0x3e0293ee
    s_mov_b32 s57, 0x3e0293ee
    s_mov_b32 s68, 0xffff0000
    s_mov_b32 s71, 0xffffff00
    v_lshlrev_b32 v27, 8, v24
    v_add_u32 v27, s100, v27
    v_lshlrev_b32 v26, 1, v24
    v_xor_b32 v5, v26, v25
    v_lshlrev_b32 v5, 4, v5
    v_lshlrev_b32 v7, 2, v27
    v_add_u32 v7, v7, v5
    v_add_u32 v5, v5, v27
    v_xor_b32 v6, v26, v25
    v_xor_b32 v6, 8, v6
    v_lshlrev_b32 v6, 4, v6
    v_lshlrev_b32 v8, 2, v27
    v_add_u32 v8, v8, v6
    v_add_u32 v8, 3072, v8
    v_add_u32 v6, v6, v27
    v_xor_b32 v26, v24, v25
    v_lshlrev_b32 v27, 8, v25
    v_xor_b32 v9, 0, v26
    v_lshlrev_b32 v9, 4, v9
    v_add_u32 v9, v9, v27
    v_xor_b32 v10, 4, v26
    v_lshlrev_b32 v10, 4, v10
    v_add_u32 v10, v10, v27
    v_xor_b32 v11, 8, v26
    v_lshlrev_b32 v11, 4, v11
    v_add_u32 v11, v11, v27
    v_xor_b32 v12, 12, v26
    v_lshlrev_b32 v12, 4, v12
    v_add_u32 v12, v12, v27
    v_lshrrev_b32 v240, 2, v25
    v_and_b32 v241, 3, v25
    v_lshlrev_b32 v26, 2, v24
    v_add_u32 v26, v26, v240
    v_lshlrev_b32 v27, 8, v26
    v_and_b32 v26, 7, v26
    v_lshlrev_b32 v26, 1, v26
    v_lshrrev_b32 v242, 1, v241
    v_xor_b32 v26, v26, v242
    v_and_b32 v242, 1, v241
    v_lshlrev_b32 v242, 3, v242
    v_add_u32 v27, v27, v242
    v_xor_b32 v13, 0, v26
    v_lshlrev_b32 v13, 4, v13
    v_add_u32 v13, v13, v27
    v_xor_b32 v14, 2, v26
    v_lshlrev_b32 v14, 4, v14
    v_add_u32 v14, v14, v27
    v_xor_b32 v15, 4, v26
    v_lshlrev_b32 v15, 4, v15
    v_add_u32 v15, v15, v27
    v_xor_b32 v16, 6, v26
    v_lshlrev_b32 v16, 4, v16
    v_add_u32 v16, v16, v27
    v_xor_b32 v17, 8, v26
    v_lshlrev_b32 v17, 4, v17
    v_add_u32 v17, v17, v27
    v_xor_b32 v18, 10, v26
    v_lshlrev_b32 v18, 4, v18
    v_add_u32 v18, v18, v27
    v_xor_b32 v19, 12, v26
    v_lshlrev_b32 v19, 4, v19
    v_add_u32 v19, v19, v27
    v_xor_b32 v20, 14, v26
    v_lshlrev_b32 v20, 4, v20
    v_add_u32 v20, v20, v27
    s_lshl_b32 s58, s53, 12
    v_add_u32 v112, s58, v9
    v_add_u32 v113, s58, v10
    v_add_u32 v114, s58, v11
    v_add_u32 v115, s58, v12
    v_lshlrev_b32 v26, 3, v24
    v_add_u32 v26, v26, v240
    v_lshlrev_b32 v26, 7, v26
    v_and_b32 v27, 1, v241
    v_lshlrev_b32 v27, 3, v27
    v_add_u32 v26, v26, v27
    v_and_b32 v27, 2, v240
    v_and_b32 v242, 1, v24
    v_lshlrev_b32 v242, 2, v242
    v_or_b32 v27, v27, v242
    v_lshrrev_b32 v242, 1, v241
    v_xor_b32 v27, v27, v242
    s_lshl_b32 s58, s54, 2
    v_xor_b32 v27, s58, v27
    v_xor_b32 v248, 0, v27
    v_lshlrev_b32 v248, 4, v248
    v_add_u32 v248, v248, v26
    v_xor_b32 v249, 2, v27
    v_lshlrev_b32 v249, 4, v249
    v_add_u32 v249, v249, v26
    v_lshrrev_b32 v250, 1, v24
    v_lshlrev_b32 v250, 3, v250
    v_and_b32 v26, 1, v24
    v_lshlrev_b32 v26, 9, v26
    v_add_u32 v250, v250, v26
    v_lshlrev_b32 v26, 4, v25
    v_add_u32 v250, v250, v26
    v_lshrrev_b32 v252, 5, v1
    v_lshlrev_b32 v252, 17, v252
    v_lshlrev_b32 v26, 2, v25
    v_add_u32 v252, v252, v26
    v_add_u32 v252, 1024, v252
    v_lshrrev_b32 v254, 1, v24
    v_lshlrev_b32 v31, 10, v25
    v_lshlrev_b32 v26, 3, v24
    v_add_u32 v31, v31, v26
    v_lshlrev_b32 v251, 7, v1
    s_lshl_b32 s59, s70, 16
    s_lshl_b32 s60, s48, 13
    s_add_u32 s59, s59, s60
    s_add_u32 s101, s59, 8388608
    s_add_u32 m0, s100, 32768
    s_add_u32 s61, s62, 256
    buffer_load_dwordx4 v244, s[28:31], s61 offen lds
    s_add_u32 m0, s100, 32768
    s_add_u32 s61, s62, 256
    buffer_load_dwordx4 v245, s[28:31], s61 offen offset:1024 lds
    s_waitcnt vmcnt(6)
    s_waitcnt vmcnt(4)
    s_barrier
    s_add_u32 m0, s100, 81920
    s_add_u32 s61, s63, 2097152
    buffer_load_dwordx4 v246, s[32:35], s61 offen lds
    s_add_u32 m0, s100, 82944
    s_add_u32 s61, s63, 2162688
    buffer_load_dwordx4 v247, s[32:35], s61 offen lds
    s_add_u32 m0, s100, 65536
    s_add_u32 s61, s62, 512
    buffer_load_dwordx4 v244, s[28:31], s61 offen lds
    s_add_u32 m0, s100, 65536
    s_add_u32 s61, s62, 512
    buffer_load_dwordx4 v245, s[28:31], s61 offen offset:1024 lds
    ds_read_b128 v[64:67], v112 offset:0
    ds_read_b64_tr_b16 v[176:177], v248 offset:16384
    ds_read_b64_tr_b16 v[178:179], v248 offset:16896
    ds_read_b64_tr_b16 v[180:181], v249 offset:16384
    ds_read_b64_tr_b16 v[182:183], v249 offset:16896
    ds_read_b128 v[68:71], v113 offset:0
    ds_read_b64_tr_b16 v[184:185], v248 offset:20480
    ds_read_b64_tr_b16 v[186:187], v248 offset:20992
    ds_read_b64_tr_b16 v[188:189], v249 offset:20480
    ds_read_b64_tr_b16 v[190:191], v249 offset:20992
    ds_read_b128 v[72:75], v114 offset:0
    ds_read_b64_tr_b16 v[192:193], v248 offset:24576
    ds_read_b64_tr_b16 v[194:195], v248 offset:25088
    ds_read_b64_tr_b16 v[196:197], v249 offset:24576
    ds_read_b64_tr_b16 v[198:199], v249 offset:25088
    ds_read_b128 v[76:79], v115 offset:0
    ds_read_b64_tr_b16 v[200:201], v248 offset:28672
    ds_read_b64_tr_b16 v[202:203], v248 offset:29184
    ds_read_b64_tr_b16 v[204:205], v249 offset:28672
    ds_read_b64_tr_b16 v[206:207], v249 offset:29184
    s_waitcnt lgkmcnt(15)
    v_mfma_f32_16x16x32_bf16 v[48:51], v[176:179], v[64:67], 0
    v_mfma_f32_16x16x32_bf16 v[52:55], v[180:183], v[64:67], 0
    s_waitcnt lgkmcnt(10)
    v_mfma_f32_16x16x32_bf16 v[48:51], v[184:187], v[68:71], v[48:51]
    v_mfma_f32_16x16x32_bf16 v[52:55], v[188:191], v[68:71], v[52:55]
    s_waitcnt lgkmcnt(5)
    v_mfma_f32_16x16x32_bf16 v[48:51], v[192:195], v[72:75], v[48:51]
    v_mfma_f32_16x16x32_bf16 v[52:55], v[196:199], v[72:75], v[52:55]
    s_waitcnt lgkmcnt(0)
    v_mfma_f32_16x16x32_bf16 v[48:51], v[200:203], v[76:79], v[48:51]
    v_mfma_f32_16x16x32_bf16 v[52:55], v[204:207], v[76:79], v[52:55]
    s_waitcnt vmcnt(6)
    s_waitcnt vmcnt(4)
    s_barrier
    s_add_u32 m0, s100, 114688
    s_add_u32 s61, s63, 3145728
    buffer_load_dwordx4 v246, s[32:35], s61 offen lds
    s_add_u32 m0, s100, 115712
    s_add_u32 s61, s63, 3211264
    buffer_load_dwordx4 v247, s[32:35], s61 offen lds
    s_add_u32 m0, s100, 98304
    s_add_u32 s61, s62, 768
    buffer_load_dwordx4 v244, s[28:31], s61 offen lds
    s_add_u32 m0, s100, 98304
    s_add_u32 s61, s62, 768
    buffer_load_dwordx4 v245, s[28:31], s61 offen offset:1024 lds
    ds_read_b128 v[64:67], v112 offset:32768
    ds_read_b64_tr_b16 v[176:177], v248 offset:49152
    ds_read_b64_tr_b16 v[178:179], v248 offset:49664
    ds_read_b64_tr_b16 v[180:181], v249 offset:49152
    ds_read_b64_tr_b16 v[182:183], v249 offset:49664
    ds_read_b128 v[68:71], v113 offset:32768
    ds_read_b64_tr_b16 v[184:185], v248 offset:53248
    ds_read_b64_tr_b16 v[186:187], v248 offset:53760
    ds_read_b64_tr_b16 v[188:189], v249 offset:53248
    ds_read_b64_tr_b16 v[190:191], v249 offset:53760
    ds_read_b128 v[72:75], v114 offset:32768
    ds_read_b64_tr_b16 v[192:193], v248 offset:57344
    ds_read_b64_tr_b16 v[194:195], v248 offset:57856
    ds_read_b64_tr_b16 v[196:197], v249 offset:57344
    ds_read_b64_tr_b16 v[198:199], v249 offset:57856
    ds_read_b128 v[76:79], v115 offset:32768
    ds_read_b64_tr_b16 v[200:201], v248 offset:61440
    ds_read_b64_tr_b16 v[202:203], v248 offset:61952
    ds_read_b64_tr_b16 v[204:205], v249 offset:61440
    ds_read_b64_tr_b16 v[206:207], v249 offset:61952
    s_waitcnt lgkmcnt(15)
    v_mfma_f32_16x16x32_bf16 v[48:51], v[176:179], v[64:67], v[48:51]
    v_mfma_f32_16x16x32_bf16 v[52:55], v[180:183], v[64:67], v[52:55]
    s_waitcnt lgkmcnt(10)
    v_mfma_f32_16x16x32_bf16 v[48:51], v[184:187], v[68:71], v[48:51]
    v_mfma_f32_16x16x32_bf16 v[52:55], v[188:191], v[68:71], v[52:55]
    s_waitcnt lgkmcnt(5)
    v_mfma_f32_16x16x32_bf16 v[48:51], v[192:195], v[72:75], v[48:51]
    v_mfma_f32_16x16x32_bf16 v[52:55], v[196:199], v[72:75], v[52:55]
    s_waitcnt lgkmcnt(0)
    v_mfma_f32_16x16x32_bf16 v[48:51], v[200:203], v[76:79], v[48:51]
    v_mfma_f32_16x16x32_bf16 v[52:55], v[204:207], v[76:79], v[52:55]
    s_waitcnt vmcnt(6)
    s_waitcnt vmcnt(4)
    s_barrier
    v_add_u32 v112, 65536, v112
    v_add_u32 v113, 65536, v113
    v_add_u32 v114, 65536, v114
    v_add_u32 v115, 65536, v115
    v_add_u32 v248, 65536, v248
    v_add_u32 v249, 65536, v249
    ds_read_b128 v[64:67], v112 offset:0
    ds_read_b64_tr_b16 v[176:177], v248 offset:16384
    ds_read_b64_tr_b16 v[178:179], v248 offset:16896
    ds_read_b64_tr_b16 v[180:181], v249 offset:16384
    ds_read_b64_tr_b16 v[182:183], v249 offset:16896
    ds_read_b128 v[68:71], v113 offset:0
    ds_read_b64_tr_b16 v[184:185], v248 offset:20480
    ds_read_b64_tr_b16 v[186:187], v248 offset:20992
    ds_read_b64_tr_b16 v[188:189], v249 offset:20480
    ds_read_b64_tr_b16 v[190:191], v249 offset:20992
    ds_read_b128 v[72:75], v114 offset:0
    ds_read_b64_tr_b16 v[192:193], v248 offset:24576
    ds_read_b64_tr_b16 v[194:195], v248 offset:25088
    ds_read_b64_tr_b16 v[196:197], v249 offset:24576
    ds_read_b64_tr_b16 v[198:199], v249 offset:25088
    ds_read_b128 v[76:79], v115 offset:0
    ds_read_b64_tr_b16 v[200:201], v248 offset:28672
    ds_read_b64_tr_b16 v[202:203], v248 offset:29184
    ds_read_b64_tr_b16 v[204:205], v249 offset:28672
    ds_read_b64_tr_b16 v[206:207], v249 offset:29184
    s_waitcnt lgkmcnt(15)
    v_mfma_f32_16x16x32_bf16 v[48:51], v[176:179], v[64:67], v[48:51]
    v_mfma_f32_16x16x32_bf16 v[52:55], v[180:183], v[64:67], v[52:55]
    s_waitcnt lgkmcnt(10)
    v_mfma_f32_16x16x32_bf16 v[48:51], v[184:187], v[68:71], v[48:51]
    v_mfma_f32_16x16x32_bf16 v[52:55], v[188:191], v[68:71], v[52:55]
    s_waitcnt lgkmcnt(5)
    v_mfma_f32_16x16x32_bf16 v[48:51], v[192:195], v[72:75], v[48:51]
    v_mfma_f32_16x16x32_bf16 v[52:55], v[196:199], v[72:75], v[52:55]
    s_waitcnt lgkmcnt(0)
    v_mfma_f32_16x16x32_bf16 v[48:51], v[200:203], v[76:79], v[48:51]
    v_mfma_f32_16x16x32_bf16 v[52:55], v[204:207], v[76:79], v[52:55]
    s_waitcnt vmcnt(2)
    s_waitcnt vmcnt(0)
    s_barrier
    s_add_u32 m0, s100, 131072
    s_mov_b32 s61, 0
    buffer_load_dwordx4 v3, s[20:23], s61 offen nt lds
    s_add_u32 m0, s100, 131072
    s_mov_b32 s61, 0
    buffer_load_dwordx4 v4, s[20:23], s61 offen offset:1024 nt lds
    ds_read_b128 v[64:67], v112 offset:32768
    ds_read_b64_tr_b16 v[176:177], v248 offset:49152
    ds_read_b64_tr_b16 v[178:179], v248 offset:49664
    ds_read_b64_tr_b16 v[180:181], v249 offset:49152
    ds_read_b64_tr_b16 v[182:183], v249 offset:49664
    ds_read_b128 v[68:71], v113 offset:32768
    ds_read_b64_tr_b16 v[184:185], v248 offset:53248
    ds_read_b64_tr_b16 v[186:187], v248 offset:53760
    ds_read_b64_tr_b16 v[188:189], v249 offset:53248
    ds_read_b64_tr_b16 v[190:191], v249 offset:53760
    ds_read_b128 v[72:75], v114 offset:32768
    ds_read_b64_tr_b16 v[192:193], v248 offset:57344
    ds_read_b64_tr_b16 v[194:195], v248 offset:57856
    ds_read_b64_tr_b16 v[196:197], v249 offset:57344
    ds_read_b64_tr_b16 v[198:199], v249 offset:57856
    ds_read_b128 v[76:79], v115 offset:32768
    ds_read_b64_tr_b16 v[200:201], v248 offset:61440
    ds_read_b64_tr_b16 v[202:203], v248 offset:61952
    ds_read_b64_tr_b16 v[204:205], v249 offset:61440
    ds_read_b64_tr_b16 v[206:207], v249 offset:61952
    s_waitcnt lgkmcnt(15)
    v_mfma_f32_16x16x32_bf16 v[48:51], v[176:179], v[64:67], v[48:51]
    v_mfma_f32_16x16x32_bf16 v[52:55], v[180:183], v[64:67], v[52:55]
    s_waitcnt lgkmcnt(10)
    v_mfma_f32_16x16x32_bf16 v[48:51], v[184:187], v[68:71], v[48:51]
    v_mfma_f32_16x16x32_bf16 v[52:55], v[188:191], v[68:71], v[52:55]
    s_waitcnt lgkmcnt(5)
    v_mfma_f32_16x16x32_bf16 v[48:51], v[192:195], v[72:75], v[48:51]
    v_mfma_f32_16x16x32_bf16 v[52:55], v[196:199], v[72:75], v[52:55]
    s_waitcnt lgkmcnt(0)
    v_mfma_f32_16x16x32_bf16 v[48:51], v[200:203], v[76:79], v[48:51]
    v_mfma_f32_16x16x32_bf16 v[52:55], v[204:207], v[76:79], v[52:55]
    s_waitcnt lgkmcnt(0)
    s_add_u32 s55, s55, 0x9e3779b9
    s_and_b32 s96, s55, 0x0fffffff
    s_lshl_b32 s97, s3, 28
    s_or_b32 s96, s96, s97
    s_mov_b32 s8, 0x00010001
    s_add_u32 s58, s55, 0
    s_and_b32 s59, s58, 1
    s_lshl_b32 s58, s58, 15
    s_and_b32 s58, s58, 0x10000
    s_or_b32 s4, s58, s59
    s_add_u32 s58, s55, 1
    s_and_b32 s59, s58, 1
    s_lshl_b32 s58, s58, 15
    s_and_b32 s58, s58, 0x10000
    s_or_b32 s5, s58, s59
    s_add_u32 s58, s55, 2
    s_and_b32 s59, s58, 1
    s_lshl_b32 s58, s58, 15
    s_and_b32 s58, s58, 0x10000
    s_or_b32 s6, s58, s59
    s_add_u32 s58, s55, 3
    s_and_b32 s59, s58, 1
    s_lshl_b32 s58, s58, 15
    s_and_b32 s58, s58, 0x10000
    s_or_b32 s7, s58, s59
    v_mov_b32 v25, s8
    v_cvt_pk_bf16_f32 v240, v48, v49
    v_cvt_pk_bf16_f32 v241, v50, v51
    v_cvt_pk_bf16_f32 v242, v52, v53
    v_cvt_pk_bf16_f32 v243, v54, v55
    v_bfi_b32 v240, v25, s4, v240
    v_bfi_b32 v241, v25, s5, v241
    v_bfi_b32 v242, v25, s6, v242
    v_bfi_b32 v243, v25, s7, v243
    v_mov_b32 v244, s96
    v_lshlrev_b32 v245, 2, v1
    s_lshl_b32 s98, s70, 14
    s_add_u32 s98, s98, s100
    s_add_u32 s98, s98, 1048576
    buffer_store_dwordx4 v[240:243], v2, s[40:43], s98 offen
    s_mov_b64 exec, 0xffff
    buffer_store_dword v244, v245, s[40:43], s98 offen offset:1024
    s_mov_b64 exec, -1
    s_barrier
    s_lshl_b32 s58, s52, 3
    s_lshl_b32 s59, s53, 1
    s_add_u32 s58, s58, s59
    s_lshl_b32 s58, s58, 3
    s_add_u32 s58, s58, s49
    s_lshl_b32 s58, s58, 14
    s_and_b32 s59, s50, 1
    s_lshl_b32 s59, s59, 1
    s_add_u32 s59, s59, s54
    s_lshl_b32 s59, s59, 12
    s_add_u32 s58, s58, s59
    s_add_u32 s62, s58, 1048576
    s_add_u32 s63, s62, 2048
    s_add_u32 s64, s62, 131072
    s_add_u32 s65, s62, 133120
    v_cmp_eq_u32 vcc, 0, v254
    v_mov_b32 v49, s6
    v_mov_b32 v51, s4
    v_cndmask_b32 v49, v49, v51, vcc
    v_mov_b32 v50, s7
    v_mov_b32 v51, s5
    v_cndmask_b32 v50, v50, v51, vcc
    s_mov_b32 s97, 0
    s_add_u32 m0, s100, 147456
    s_mov_b32 s61, 16384
    buffer_load_dwordx4 v3, s[20:23], s61 offen nt lds
    s_add_u32 m0, s100, 147456
    s_mov_b32 s61, 16384
    buffer_load_dwordx4 v4, s[20:23], s61 offen offset:1024 nt lds
    s_cmp_lg_u32 s97, 0
    s_cbranch_scc1 L_qskip2
    buffer_load_dwordx2 v[32:33], v250, s[40:43], s62 offen offset:0 sc1
    buffer_load_dwordx2 v[34:35], v250, s[40:43], s62 offen offset:256 sc1
    buffer_load_dwordx2 v[36:37], v250, s[40:43], s63 offen offset:0 sc1
    buffer_load_dwordx2 v[38:39], v250, s[40:43], s63 offen offset:256 sc1
    buffer_load_dwordx2 v[40:41], v250, s[40:43], s64 offen offset:0 sc1
    buffer_load_dwordx2 v[42:43], v250, s[40:43], s64 offen offset:256 sc1
    buffer_load_dwordx2 v[44:45], v250, s[40:43], s65 offen offset:0 sc1
    buffer_load_dwordx2 v[46:47], v250, s[40:43], s65 offen offset:256 sc1
    buffer_load_dword v48, v252, s[40:43], s62 offen sc1
    s_waitcnt vmcnt(0)
    v_xor_b32 v25, v49, v32
    v_xor_b32 v30, v50, v33
    v_or_b32 v25, v25, v30
    v_xor_b32 v30, v49, v34
    v_or_b32 v25, v25, v30
    v_xor_b32 v30, v50, v35
    v_or_b32 v25, v25, v30
    v_xor_b32 v30, v49, v36
    v_or_b32 v25, v25, v30
    v_xor_b32 v30, v50, v37
    v_or_b32 v25, v25, v30
    v_xor_b32 v30, v49, v38
    v_or_b32 v25, v25, v30
    v_xor_b32 v30, v50, v39
    v_or_b32 v25, v25, v30
    v_xor_b32 v30, v49, v40
    v_or_b32 v25, v25, v30
    v_xor_b32 v30, v50, v41
    v_or_b32 v25, v25, v30
    v_xor_b32 v30, v49, v42
    v_or_b32 v25, v25, v30
    v_xor_b32 v30, v50, v43
    v_or_b32 v25, v25, v30
    v_xor_b32 v30, v49, v44
    v_or_b32 v25, v25, v30
    v_xor_b32 v30, v50, v45
    v_or_b32 v25, v25, v30
    v_xor_b32 v30, v49, v46
    v_or_b32 v25, v25, v30
    v_xor_b32 v30, v50, v47
    v_or_b32 v25, v25, v30
    v_and_b32 v25, s8, v25
    v_xor_b32 v51, s96, v48
    v_and_b32 v30, 0x0fffffff, v51
    v_or_b32 v25, v25, v30
    v_cmp_ne_u32 vcc, 0, v25
    s_cbranch_vccnz L_qskip2
    s_mov_b32 s97, 1
L_qskip2:
    s_add_u32 m0, s100, 0
    s_mov_b32 s61, 32768
    buffer_load_dwordx4 v3, s[20:23], s61 offen nt lds
    s_add_u32 m0, s100, 0
    s_mov_b32 s61, 32768
    buffer_load_dwordx4 v4, s[20:23], s61 offen offset:1024 nt lds
    s_cmp_lg_u32 s97, 0
    s_cbranch_scc1 L_qskip3
    buffer_load_dwordx2 v[32:33], v250, s[40:43], s62 offen offset:0 sc1
    buffer_load_dwordx2 v[34:35], v250, s[40:43], s62 offen offset:256 sc1
    buffer_load_dwordx2 v[36:37], v250, s[40:43], s63 offen offset:0 sc1
    buffer_load_dwordx2 v[38:39], v250, s[40:43], s63 offen offset:256 sc1
    buffer_load_dwordx2 v[40:41], v250, s[40:43], s64 offen offset:0 sc1
    buffer_load_dwordx2 v[42:43], v250, s[40:43], s64 offen offset:256 sc1
    buffer_load_dwordx2 v[44:45], v250, s[40:43], s65 offen offset:0 sc1
    buffer_load_dwordx2 v[46:47], v250, s[40:43], s65 offen offset:256 sc1
    buffer_load_dword v48, v252, s[40:43], s62 offen sc1
    s_waitcnt vmcnt(0)
    v_xor_b32 v25, v49, v32
    v_xor_b32 v30, v50, v33
    v_or_b32 v25, v25, v30
    v_xor_b32 v30, v49, v34
    v_or_b32 v25, v25, v30
    v_xor_b32 v30, v50, v35
    v_or_b32 v25, v25, v30
    v_xor_b32 v30, v49, v36
    v_or_b32 v25, v25, v30
    v_xor_b32 v30, v50, v37
    v_or_b32 v25, v25, v30
    v_xor_b32 v30, v49, v38
    v_or_b32 v25, v25, v30
    v_xor_b32 v30, v50, v39
    v_or_b32 v25, v25, v30
    v_xor_b32 v30, v49, v40
    v_or_b32 v25, v25, v30
    v_xor_b32 v30, v50, v41
    v_or_b32 v25, v25, v30
    v_xor_b32 v30, v49, v42
    v_or_b32 v25, v25, v30
    v_xor_b32 v30, v50, v43
    v_or_b32 v25, v25, v30
    v_xor_b32 v30, v49, v44
    v_or_b32 v25, v25, v30
    v_xor_b32 v30, v50, v45
    v_or_b32 v25, v25, v30
    v_xor_b32 v30, v49, v46
    v_or_b32 v25, v25, v30
    v_xor_b32 v30, v50, v47
    v_or_b32 v25, v25, v30
    v_and_b32 v25, s8, v25
    v_xor_b32 v51, s96, v48
    v_and_b32 v30, 0x0fffffff, v51
    v_or_b32 v25, v25, v30
    v_cmp_ne_u32 vcc, 0, v25
    s_cbranch_vccnz L_qskip3
    s_mov_b32 s97, 1
L_qskip3:
    s_cmp_lg_u32 s97, 0
    s_cselect_b64 vcc, 0, -1
    s_cbranch_vccz L_qok5
    s_mov_b32 s69, 0
L_qretry4:
    s_cmp_lg_u32 s69, 2
    s_cbranch_scc1 L_qnore6
    buffer_store_dwordx4 v[240:243], v2, s[40:43], s98 offen sc1
    s_mov_b64 exec, 0xffff
    buffer_store_dword v244, v245, s[40:43], s98 offen offset:1024 sc1
    s_mov_b64 exec, -1
L_qnore6:
    s_sleep 1
    buffer_load_dwordx2 v[32:33], v250, s[40:43], s62 offen offset:0 sc1
    buffer_load_dwordx2 v[34:35], v250, s[40:43], s62 offen offset:256 sc1
    buffer_load_dwordx2 v[36:37], v250, s[40:43], s63 offen offset:0 sc1
    buffer_load_dwordx2 v[38:39], v250, s[40:43], s63 offen offset:256 sc1
    buffer_load_dwordx2 v[40:41], v250, s[40:43], s64 offen offset:0 sc1
    buffer_load_dwordx2 v[42:43], v250, s[40:43], s64 offen offset:256 sc1
    buffer_load_dwordx2 v[44:45], v250, s[40:43], s65 offen offset:0 sc1
    buffer_load_dwordx2 v[46:47], v250, s[40:43], s65 offen offset:256 sc1
    buffer_load_dword v48, v252, s[40:43], s62 offen sc1
    s_waitcnt vmcnt(0)
    v_xor_b32 v25, v49, v32
    v_xor_b32 v30, v50, v33
    v_or_b32 v25, v25, v30
    v_xor_b32 v30, v49, v34
    v_or_b32 v25, v25, v30
    v_xor_b32 v30, v50, v35
    v_or_b32 v25, v25, v30
    v_xor_b32 v30, v49, v36
    v_or_b32 v25, v25, v30
    v_xor_b32 v30, v50, v37
    v_or_b32 v25, v25, v30
    v_xor_b32 v30, v49, v38
    v_or_b32 v25, v25, v30
    v_xor_b32 v30, v50, v39
    v_or_b32 v25, v25, v30
    v_xor_b32 v30, v49, v40
    v_or_b32 v25, v25, v30
    v_xor_b32 v30, v50, v41
    v_or_b32 v25, v25, v30
    v_xor_b32 v30, v49, v42
    v_or_b32 v25, v25, v30
    v_xor_b32 v30, v50, v43
    v_or_b32 v25, v25, v30
    v_xor_b32 v30, v49, v44
    v_or_b32 v25, v25, v30
    v_xor_b32 v30, v50, v45
    v_or_b32 v25, v25, v30
    v_xor_b32 v30, v49, v46
    v_or_b32 v25, v25, v30
    v_xor_b32 v30, v50, v47
    v_or_b32 v25, v25, v30
    v_and_b32 v25, s8, v25
    v_xor_b32 v51, s96, v48
    v_and_b32 v30, 0x0fffffff, v51
    v_or_b32 v25, v25, v30
    v_cmp_ne_u32 vcc, 0, v25
    s_add_u32 s69, s69, 1
    s_cmp_gt_u32 s69, 200000
    s_cbranch_scc1 L_qok5
    s_cbranch_vccnz L_qretry4
L_qok5:
    s_nop 7
    v_cmp_ne_u32 vcc, 0, v51
    s_nop 3
    s_cmp_lg_u64 vcc, 0
    s_cselect_b32 s58, 1, 0
    s_add_u32 s58, s58, s55
    v_mov_b32 v30, s58
    s_lshl_b32 s58, s48, 2
    s_add_u32 s58, s58, 114688
    v_mov_b32 v25, s58
    ds_write_b32 v25, v30
    v_and_b32 v25, 7, v1
    v_lshlrev_b32 v25, 2, v25
    v_add_u32 v25, 114688, v25
    s_mov_b32 s69, 0
L_vote7:
    ds_read_b32 v30, v25
    s_waitcnt lgkmcnt(0)
    v_subrev_u32 v30, s55, v30
    v_cmp_lt_u32 vcc, 1, v30
    s_cbranch_vccz L_voteok8
    s_add_u32 s69, s69, 1
    s_cmp_lg_u32 s69, 30
    s_cbranch_scc1 L_votenore9
    buffer_store_dwordx4 v[240:243], v2, s[40:43], s98 offen sc1
    s_mov_b64 exec, 0xffff
    buffer_store_dword v244, v245, s[40:43], s98 offen offset:1024 sc1
    s_mov_b64 exec, -1
L_votenore9:
    s_cmp_gt_u32 s69, 800000
    s_cbranch_scc1 L_voteok8
    s_sleep 1
    s_branch L_vote7
L_voteok8:
    v_cmp_ne_u32 vcc, 0, v30
    s_nop 3
    s_cmp_eq_u64 vcc, 0
    s_cselect_b32 s3, 1, 0
    s_cmp_eq_u32 s3, 1
    s_cbranch_scc1 L_loc10
    buffer_store_dwordx4 v[240:243], v2, s[40:43], s98 offen sc1
    s_mov_b64 exec, 0xffff
    buffer_store_dword v244, v245, s[40:43], s98 offen offset:1024 sc1
    s_mov_b64 exec, -1
L_loc10:
    v_mov_b32 v29, v251
    v_add_u32 v9, 131072, v9
    v_add_u32 v10, 131072, v10
    v_add_u32 v11, 131072, v11
    v_add_u32 v12, 131072, v12
    ds_read_b128 v[176:179], v9 offset:0
    ds_read_b128 v[192:195], v9 offset:4096
    ds_read_b128 v[180:183], v10 offset:0
    ds_read_b128 v[196:199], v10 offset:4096
    ds_read_b128 v[184:187], v11 offset:0
    ds_read_b128 v[200:203], v11 offset:4096
    ds_read_b128 v[188:191], v12 offset:0
    ds_read_b128 v[204:207], v12 offset:4096
    s_waitcnt lgkmcnt(7)
    v_mfma_f32_16x16x32_bf16 v[48:51], v[176:179], v[32:35], 0
    ds_read_b128 v[208:211], v9 offset:8192
    s_waitcnt lgkmcnt(7)
    v_mfma_f32_16x16x32_bf16 v[52:55], v[192:195], v[32:35], 0
    ds_read_b128 v[224:227], v9 offset:12288
    s_waitcnt lgkmcnt(7)
    v_mfma_f32_16x16x32_bf16 v[48:51], v[180:183], v[36:39], v[48:51]
    ds_read_b128 v[212:215], v10 offset:8192
    ds_read_b128 v[228:231], v10 offset:12288
    s_waitcnt lgkmcnt(8)
    v_mfma_f32_16x16x32_bf16 v[52:55], v[196:199], v[36:39], v[52:55]
    ds_read_b128 v[216:219], v11 offset:8192
    s_waitcnt lgkmcnt(8)
    v_mfma_f32_16x16x32_bf16 v[48:51], v[184:187], v[40:43], v[48:51]
    ds_read_b128 v[232:235], v11 offset:12288
    s_waitcnt lgkmcnt(8)
    v_mfma_f32_16x16x32_bf16 v[52:55], v[200:203], v[40:43], v[52:55]
    ds_read_b128 v[220:223], v12 offset:8192
    ds_read_b128 v[236:239], v12 offset:12288
    s_waitcnt lgkmcnt(9)
    v_mfma_f32_16x16x32_bf16 v[48:51], v[188:191], v[44:47], v[48:51]
    s_add_u32 m0, s100, 16384
    s_mov_b32 s61, 49152
    buffer_load_dwordx4 v3, s[20:23], s61 offen nt lds
    s_waitcnt lgkmcnt(8)
    v_mfma_f32_16x16x32_bf16 v[52:55], v[204:207], v[44:47], v[52:55]
    s_waitcnt lgkmcnt(7)
    v_mfma_f32_16x16x32_bf16 v[56:59], v[208:211], v[32:35], 0
    ds_read_b128 v[176:179], v9 offset:16384
    s_waitcnt lgkmcnt(7)
    v_mfma_f32_16x16x32_bf16 v[60:63], v[224:227], v[32:35], 0
    ds_read_b128 v[192:195], v9 offset:20480
    s_waitcnt lgkmcnt(7)
    v_mfma_f32_16x16x32_bf16 v[56:59], v[212:215], v[36:39], v[56:59]
    ds_read_b128 v[180:183], v10 offset:16384
    ds_read_b128 v[196:199], v10 offset:20480
    s_waitcnt lgkmcnt(8)
    v_mfma_f32_16x16x32_bf16 v[60:63], v[228:231], v[36:39], v[60:63]
    ds_read_b128 v[184:187], v11 offset:16384
    s_waitcnt lgkmcnt(8)
    v_mfma_f32_16x16x32_bf16 v[56:59], v[216:219], v[40:43], v[56:59]
    ds_read_b128 v[200:203], v11 offset:20480
    s_waitcnt lgkmcnt(8)
    v_mfma_f32_16x16x32_bf16 v[60:63], v[232:235], v[40:43], v[60:63]
    ds_read_b128 v[188:191], v12 offset:16384
    ds_read_b128 v[204:207], v12 offset:20480
    s_waitcnt lgkmcnt(9)
    v_mfma_f32_16x16x32_bf16 v[56:59], v[220:223], v[44:47], v[56:59]
    s_add_u32 m0, s100, 16384
    s_mov_b32 s61, 49152
    buffer_load_dwordx4 v4, s[20:23], s61 offen offset:1024 nt lds
    s_waitcnt lgkmcnt(8)
    v_mfma_f32_16x16x32_bf16 v[60:63], v[236:239], v[44:47], v[60:63]
    s_waitcnt lgkmcnt(7)
    v_mfma_f32_16x16x32_bf16 v[64:67], v[176:179], v[32:35], 0
    ds_read_b128 v[208:211], v9 offset:24576
    v_max3_f32 v0, v48, v49, v50
    s_waitcnt lgkmcnt(7)
    v_mfma_f32_16x16x32_bf16 v[68:71], v[192:195], v[32:35], 0
    ds_read_b128 v[224:227], v9 offset:28672
    v_max3_f32 v0, v0, v51, v52
    s_waitcnt lgkmcnt(7)
    v_mfma_f32_16x16x32_bf16 v[64:67], v[180:183], v[36:39], v[64:67]
    ds_read_b128 v[212:215], v10 offset:24576
    ds_read_b128 v[228:231], v10 offset:28672
    v_max3_f32 v0, v0, v53, v54
    s_waitcnt lgkmcnt(8)
    v_mfma_f32_16x16x32_bf16 v[68:71], v[196:199], v[36:39], v[68:71]
    ds_read_b128 v[216:219], v11 offset:24576
    v_max3_f32 v0, v0, v55, v56
    s_waitcnt lgkmcnt(8)
    v_mfma_f32_16x16x32_bf16 v[64:67], v[184:187], v[40:43], v[64:67]
    ds_read_b128 v[232:235], v11 offset:28672
    v_max3_f32 v0, v0, v57, v58
    s_waitcnt lgkmcnt(8)
    v_mfma_f32_16x16x32_bf16 v[68:71], v[200:203], v[40:43], v[68:71]
    ds_read_b128 v[220:223], v12 offset:24576
    ds_read_b128 v[236:239], v12 offset:28672
    v_max3_f32 v0, v0, v59, v60
    s_waitcnt lgkmcnt(9)
    v_mfma_f32_16x16x32_bf16 v[64:67], v[188:191], v[44:47], v[64:67]
    s_waitcnt vmcnt(3)
    s_add_u32 m0, s100, 32768
    s_mov_b32 s61, 65536
    buffer_load_dwordx4 v3, s[20:23], s61 offen nt lds
    v_max3_f32 v0, v0, v61, v62
    s_waitcnt lgkmcnt(8)
    v_mfma_f32_16x16x32_bf16 v[68:71], v[204:207], v[44:47], v[68:71]
    v_max_f32 v0, v0, v63
    s_waitcnt vmcnt(3)
    s_barrier
    s_waitcnt lgkmcnt(7)
    v_mfma_f32_16x16x32_bf16 v[72:75], v[208:211], v[32:35], 0
    v_add_u32 v9, -131072, v9
    v_add_u32 v10, -131072, v10
    s_waitcnt lgkmcnt(6)
    v_mfma_f32_16x16x32_bf16 v[76:79], v[224:227], v[32:35], 0
    v_add_u32 v11, -131072, v11
    v_add_u32 v12, -131072, v12
    s_waitcnt lgkmcnt(5)
    v_mfma_f32_16x16x32_bf16 v[72:75], v[212:215], v[36:39], v[72:75]
    ds_read_b128 v[176:179], v9 offset:0
    ds_read_b128 v[192:195], v9 offset:4096
    s_waitcnt lgkmcnt(6)
    v_mfma_f32_16x16x32_bf16 v[76:79], v[228:231], v[36:39], v[76:79]
    ds_read_b128 v[180:183], v10 offset:0
    ds_read_b128 v[196:199], v10 offset:4096
    s_waitcnt lgkmcnt(7)
    v_mfma_f32_16x16x32_bf16 v[72:75], v[216:219], v[40:43], v[72:75]
    ds_read_b128 v[184:187], v11 offset:0
    ds_read_b128 v[200:203], v11 offset:4096
    s_waitcnt lgkmcnt(8)
    v_mfma_f32_16x16x32_bf16 v[76:79], v[232:235], v[40:43], v[76:79]
    ds_read_b128 v[188:191], v12 offset:0
    ds_read_b128 v[204:207], v12 offset:4096
    s_waitcnt lgkmcnt(9)
    v_mfma_f32_16x16x32_bf16 v[72:75], v[220:223], v[44:47], v[72:75]
    s_add_u32 m0, s100, 32768
    s_mov_b32 s61, 65536
    buffer_load_dwordx4 v4, s[20:23], s61 offen offset:1024 nt lds
    s_waitcnt lgkmcnt(8)
    v_mfma_f32_16x16x32_bf16 v[76:79], v[236:239], v[44:47], v[76:79]
    s_waitcnt lgkmcnt(7)
    v_mfma_f32_16x16x32_bf16 v[80:83], v[176:179], v[32:35], 0
    ds_read_b128 v[208:211], v9 offset:8192
    v_max3_f32 v0, v0, v64, v65
    v_max3_f32 v0, v0, v66, v67
    s_waitcnt lgkmcnt(7)
    v_mfma_f32_16x16x32_bf16 v[84:87], v[192:195], v[32:35], 0
    ds_read_b128 v[224:227], v9 offset:12288
    v_max3_f32 v0, v0, v68, v69
    v_max3_f32 v0, v0, v70, v71
    s_waitcnt lgkmcnt(7)
    v_mfma_f32_16x16x32_bf16 v[80:83], v[180:183], v[36:39], v[80:83]
    ds_read_b128 v[212:215], v10 offset:8192
    ds_read_b128 v[228:231], v10 offset:12288
    v_max3_f32 v0, v0, v72, v73
    v_max3_f32 v0, v0, v74, v75
    v_max3_f32 v0, v0, v76, v77
    s_waitcnt lgkmcnt(8)
    v_mfma_f32_16x16x32_bf16 v[84:87], v[196:199], v[36:39], v[84:87]
    ds_read_b128 v[216:219], v11 offset:8192
    v_max3_f32 v0, v0, v78, v79
    v_mov_b32 v23, v0
    s_waitcnt lgkmcnt(8)
    v_mfma_f32_16x16x32_bf16 v[80:83], v[184:187], v[40:43], v[80:83]
    ds_read_b128 v[232:235], v11 offset:12288
    s_nop 1
    v_permlane32_swap_b32 v0, v23
    s_waitcnt lgkmcnt(8)
    v_mfma_f32_16x16x32_bf16 v[84:87], v[200:203], v[40:43], v[84:87]
    ds_read_b128 v[220:223], v12 offset:8192
    ds_read_b128 v[236:239], v12 offset:12288
    s_nop 0
    v_max_f32 v0, v0, v23
    v_mov_b32 v23, v0
    s_waitcnt lgkmcnt(9)
    v_mfma_f32_16x16x32_bf16 v[80:83], v[188:191], v[44:47], v[80:83]
    s_waitcnt vmcnt(3)
    s_add_u32 m0, s100, 49152
    s_mov_b32 s61, 81920
    buffer_load_dwordx4 v3, s[20:23], s61 offen nt lds
    s_nop 1
    v_permlane16_swap_b32 v0, v23
    s_waitcnt lgkmcnt(8)
    v_mfma_f32_16x16x32_bf16 v[84:87], v[204:207], v[44:47], v[84:87]
    s_nop 0
    v_max_f32 v0, v0, v23
    v_mul_f32 v0, s56, v0
    s_waitcnt vmcnt(3)
    s_barrier
    s_waitcnt lgkmcnt(7)
    v_mfma_f32_16x16x32_bf16 v[88:91], v[208:211], v[32:35], 0
    ds_read_b128 v[176:179], v9 offset:16384
    v_pk_fma_f32 v[48:49], v[48:49], s[56:57], v[0:1] op_sel_hi:[1,0,0] neg_lo:[0,0,1] neg_hi:[0,0,1]
    s_waitcnt lgkmcnt(7)
    v_mfma_f32_16x16x32_bf16 v[92:95], v[224:227], v[32:35], 0
    ds_read_b128 v[192:195], v9 offset:20480
    v_pk_fma_f32 v[50:51], v[50:51], s[56:57], v[0:1] op_sel_hi:[1,0,0] neg_lo:[0,0,1] neg_hi:[0,0,1]
    v_pk_fma_f32 v[52:53], v[52:53], s[56:57], v[0:1] op_sel_hi:[1,0,0] neg_lo:[0,0,1] neg_hi:[0,0,1]
    s_waitcnt lgkmcnt(7)
    v_mfma_f32_16x16x32_bf16 v[88:91], v[212:215], v[36:39], v[88:91]
    ds_read_b128 v[180:183], v10 offset:16384
    ds_read_b128 v[196:199], v10 offset:20480
    v_pk_fma_f32 v[54:55], v[54:55], s[56:57], v[0:1] op_sel_hi:[1,0,0] neg_lo:[0,0,1] neg_hi:[0,0,1]
    v_exp_f32 v48, v48
    s_waitcnt lgkmcnt(8)
    v_mfma_f32_16x16x32_bf16 v[92:95], v[228:231], v[36:39], v[92:95]
    ds_read_b128 v[184:187], v11 offset:16384
    v_exp_f32 v49, v49
    v_exp_f32 v50, v50
    s_waitcnt lgkmcnt(8)
    v_mfma_f32_16x16x32_bf16 v[88:91], v[216:219], v[40:43], v[88:91]
    ds_read_b128 v[200:203], v11 offset:20480
    v_exp_f32 v51, v51
    v_exp_f32 v52, v52
    s_waitcnt lgkmcnt(8)
    v_mfma_f32_16x16x32_bf16 v[92:95], v[232:235], v[40:43], v[92:95]
    ds_read_b128 v[188:191], v12 offset:16384
    ds_read_b128 v[204:207], v12 offset:20480
    v_exp_f32 v53, v53
    v_exp_f32 v54, v54
    s_waitcnt lgkmcnt(9)
    v_mfma_f32_16x16x32_bf16 v[88:91], v[220:223], v[44:47], v[88:91]
    s_add_u32 m0, s100, 49152
    s_mov_b32 s61, 81920
    buffer_load_dwordx4 v4, s[20:23], s61 offen offset:1024 nt lds
    v_exp_f32 v55, v55
    v_mov_b32 v21, v48
    s_waitcnt lgkmcnt(8)
    v_mfma_f32_16x16x32_bf16 v[92:95], v[236:239], v[44:47], v[92:95]
    v_mov_b32 v28, v49
    v_cvt_pk_bf16_f32 v48, v48, v49
    s_waitcnt lgkmcnt(7)
    v_mfma_f32_16x16x32_bf16 v[96:99], v[176:179], v[32:35], 0
    ds_read_b128 v[208:211], v9 offset:24576
    v_max3_f32 v22, v80, v81, v82
    v_max3_f32 v22, v22, v83, v84
    s_waitcnt lgkmcnt(7)
    v_mfma_f32_16x16x32_bf16 v[100:103], v[192:195], v[32:35], 0
    ds_read_b128 v[224:227], v9 offset:28672
    v_max3_f32 v22, v22, v85, v86
    v_max3_f32 v22, v22, v87, v88
    v_max3_f32 v22, v22, v89, v90
    s_waitcnt lgkmcnt(7)
    v_mfma_f32_16x16x32_bf16 v[96:99], v[180:183], v[36:39], v[96:99]
    ds_read_b128 v[212:215], v10 offset:24576
    ds_read_b128 v[228:231], v10 offset:28672
    v_max3_f32 v22, v22, v91, v92
    v_max3_f32 v22, v22, v93, v94
    v_max_f32 v22, v22, v95
    s_waitcnt lgkmcnt(8)
    v_mfma_f32_16x16x32_bf16 v[100:103], v[196:199], v[36:39], v[100:103]
    ds_read_b128 v[216:219], v11 offset:24576
    v_add_f32 v21, v21, v50
    v_add_f32 v28, v28, v51
    v_cvt_pk_bf16_f32 v49, v50, v51
    s_waitcnt lgkmcnt(8)
    v_mfma_f32_16x16x32_bf16 v[96:99], v[184:187], v[40:43], v[96:99]
    ds_read_b128 v[232:235], v11 offset:28672
    v_add_f32 v21, v21, v52
    v_add_f32 v28, v28, v53
    s_waitcnt lgkmcnt(8)
    v_mfma_f32_16x16x32_bf16 v[100:103], v[200:203], v[40:43], v[100:103]
    ds_read_b128 v[220:223], v12 offset:24576
    ds_read_b128 v[236:239], v12 offset:28672
    v_cvt_pk_bf16_f32 v50, v52, v53
    v_add_f32 v21, v21, v54
    v_add_f32 v28, v28, v55
    s_waitcnt lgkmcnt(9)
    v_mfma_f32_16x16x32_bf16 v[96:99], v[188:191], v[44:47], v[96:99]
    s_waitcnt vmcnt(3)
    s_add_u32 m0, s100, 65536
    s_mov_b32 s61, 98304
    buffer_load_dwordx4 v3, s[20:23], s61 offen nt lds
    v_cvt_pk_bf16_f32 v51, v54, v55
    v_pk_fma_f32 v[56:57], v[56:57], s[56:57], v[0:1] op_sel_hi:[1,0,0] neg_lo:[0,0,1] neg_hi:[0,0,1]
    v_pk_fma_f32 v[58:59], v[58:59], s[56:57], v[0:1] op_sel_hi:[1,0,0] neg_lo:[0,0,1] neg_hi:[0,0,1]
    s_waitcnt lgkmcnt(8)
    v_mfma_f32_16x16x32_bf16 v[100:103], v[204:207], v[44:47], v[100:103]
    v_pk_fma_f32 v[60:61], v[60:61], s[56:57], v[0:1] op_sel_hi:[1,0,0] neg_lo:[0,0,1] neg_hi:[0,0,1]
    v_pk_fma_f32 v[62:63], v[62:63], s[56:57], v[0:1] op_sel_hi:[1,0,0] neg_lo:[0,0,1] neg_hi:[0,0,1]
    v_exp_f32 v56, v56
    s_waitcnt vmcnt(3)
    s_barrier
    s_waitcnt lgkmcnt(7)
    v_mfma_f32_16x16x32_bf16 v[104:107], v[208:211], v[32:35], 0
    ds_read_b128 v[176:179], v9 offset:32768
    v_exp_f32 v57, v57
    v_exp_f32 v58, v58
    s_waitcnt lgkmcnt(7)
    v_mfma_f32_16x16x32_bf16 v[108:111], v[224:227], v[32:35], 0
    ds_read_b128 v[192:195], v9 offset:36864
    v_exp_f32 v59, v59
    v_exp_f32 v60, v60
    s_waitcnt lgkmcnt(7)
    v_mfma_f32_16x16x32_bf16 v[104:107], v[212:215], v[36:39], v[104:107]
    ds_read_b128 v[180:183], v10 offset:32768
    ds_read_b128 v[196:199], v10 offset:36864
    v_exp_f32 v61, v61
    v_exp_f32 v62, v62
    v_exp_f32 v63, v63
    s_waitcnt lgkmcnt(8)
    v_mfma_f32_16x16x32_bf16 v[108:111], v[228:231], v[36:39], v[108:111]
    ds_read_b128 v[184:187], v11 offset:32768
    v_add_f32 v21, v21, v56
    v_add_f32 v28, v28, v57
    s_waitcnt lgkmcnt(8)
    v_mfma_f32_16x16x32_bf16 v[104:107], v[216:219], v[40:43], v[104:107]
    ds_read_b128 v[200:203], v11 offset:36864
    v_cvt_pk_bf16_f32 v52, v56, v57
    v_add_f32 v21, v21, v58
    s_waitcnt lgkmcnt(8)
    v_mfma_f32_16x16x32_bf16 v[108:111], v[232:235], v[40:43], v[108:111]
    ds_read_b128 v[188:191], v12 offset:32768
    ds_read_b128 v[204:207], v12 offset:36864
    v_add_f32 v28, v28, v59
    v_cvt_pk_bf16_f32 v53, v58, v59
    v_add_f32 v21, v21, v60
    s_waitcnt lgkmcnt(9)
    v_mfma_f32_16x16x32_bf16 v[104:107], v[220:223], v[44:47], v[104:107]
    s_add_u32 m0, s100, 65536
    s_mov_b32 s61, 98304
    buffer_load_dwordx4 v4, s[20:23], s61 offen offset:1024 nt lds
    v_add_f32 v28, v28, v61
    v_cvt_pk_bf16_f32 v54, v60, v61
    s_waitcnt lgkmcnt(8)
    v_mfma_f32_16x16x32_bf16 v[108:111], v[236:239], v[44:47], v[108:111]
    v_add_f32 v21, v21, v62
    v_add_f32 v28, v28, v63
    v_cvt_pk_bf16_f32 v55, v62, v63
    s_barrier
    s_waitcnt lgkmcnt(7)
    v_mfma_f32_16x16x32_bf16 v[112:115], v[176:179], v[32:35], 0
    ds_read_b128 v[208:211], v9 offset:40960
    v_max3_f32 v22, v22, v96, v97
    v_max3_f32 v22, v22, v98, v99
    v_max3_f32 v22, v22, v100, v101
    s_waitcnt lgkmcnt(7)
    v_mfma_f32_16x16x32_bf16 v[116:119], v[192:195], v[32:35], 0
    ds_read_b128 v[224:227], v9 offset:45056
    v_max3_f32 v22, v22, v102, v103
    v_max3_f32 v22, v22, v104, v105
    v_max3_f32 v22, v22, v106, v107
    s_waitcnt lgkmcnt(7)
    v_mfma_f32_16x16x32_bf16 v[112:115], v[180:183], v[36:39], v[112:115]
    ds_read_b128 v[212:215], v10 offset:40960
    ds_read_b128 v[228:231], v10 offset:45056
    v_max3_f32 v22, v22, v108, v109
    v_max3_f32 v22, v22, v110, v111
    v_mov_b32 v23, v22
    s_waitcnt lgkmcnt(8)
    v_mfma_f32_16x16x32_bf16 v[116:119], v[196:199], v[36:39], v[116:119]
    ds_read_b128 v[216:219], v11 offset:40960
    s_nop 1
    v_permlane32_swap_b32 v22, v23
    s_nop 0
    s_waitcnt lgkmcnt(8)
    v_mfma_f32_16x16x32_bf16 v[112:115], v[184:187], v[40:43], v[112:115]
    ds_read_b128 v[232:235], v11 offset:45056
    v_max_f32 v22, v22, v23
    v_mov_b32 v23, v22
    s_nop 1
    s_waitcnt lgkmcnt(8)
    v_mfma_f32_16x16x32_bf16 v[116:119], v[200:203], v[40:43], v[116:119]
    ds_read_b128 v[220:223], v12 offset:40960
    ds_read_b128 v[236:239], v12 offset:45056
    v_permlane16_swap_b32 v22, v23
    s_nop 0
    v_max_f32 v22, v22, v23
    s_waitcnt lgkmcnt(9)
    v_mfma_f32_16x16x32_bf16 v[112:115], v[188:191], v[44:47], v[112:115]
    s_waitcnt vmcnt(3)
    s_add_u32 m0, s100, 81920
    s_mov_b32 s61, 114688
    buffer_load_dwordx4 v3, s[20:23], s61 offen nt lds
    v_mul_f32 v22, s56, v22
    v_max_f32 v22, v22, v0
    v_sub_f32 v26, v0, v22
    s_waitcnt lgkmcnt(8)
    v_mfma_f32_16x16x32_bf16 v[116:119], v[204:207], v[44:47], v[116:119]
    v_exp_f32 v26, v26
    v_pk_fma_f32 v[64:65], v[64:65], s[56:57], v[0:1] op_sel_hi:[1,0,0] neg_lo:[0,0,1] neg_hi:[0,0,1]
    v_pk_fma_f32 v[66:67], v[66:67], s[56:57], v[0:1] op_sel_hi:[1,0,0] neg_lo:[0,0,1] neg_hi:[0,0,1]
    s_waitcnt vmcnt(3)
    s_barrier
    s_waitcnt lgkmcnt(7)
    v_mfma_f32_16x16x32_bf16 v[120:123], v[208:211], v[32:35], 0
    ds_read_b128 v[176:179], v9 offset:49152
    v_pk_fma_f32 v[68:69], v[68:69], s[56:57], v[0:1] op_sel_hi:[1,0,0] neg_lo:[0,0,1] neg_hi:[0,0,1]
    v_pk_fma_f32 v[70:71], v[70:71], s[56:57], v[0:1] op_sel_hi:[1,0,0] neg_lo:[0,0,1] neg_hi:[0,0,1]
    s_waitcnt lgkmcnt(7)
    v_mfma_f32_16x16x32_bf16 v[124:127], v[224:227], v[32:35], 0
    ds_read_b128 v[192:195], v9 offset:53248
    v_exp_f32 v64, v64
    v_exp_f32 v65, v65
    s_waitcnt lgkmcnt(7)
    v_mfma_f32_16x16x32_bf16 v[120:123], v[212:215], v[36:39], v[120:123]
    ds_read_b128 v[180:183], v10 offset:49152
    ds_read_b128 v[196:199], v10 offset:53248
    v_exp_f32 v66, v66
    v_exp_f32 v67, v67
    s_waitcnt lgkmcnt(8)
    v_mfma_f32_16x16x32_bf16 v[124:127], v[228:231], v[36:39], v[124:127]
    ds_read_b128 v[184:187], v11 offset:49152
    v_exp_f32 v68, v68
    v_exp_f32 v69, v69
    s_waitcnt lgkmcnt(8)
    v_mfma_f32_16x16x32_bf16 v[120:123], v[216:219], v[40:43], v[120:123]
    ds_read_b128 v[200:203], v11 offset:53248
    v_exp_f32 v70, v70
    v_exp_f32 v71, v71
    s_waitcnt lgkmcnt(8)
    v_mfma_f32_16x16x32_bf16 v[124:127], v[232:235], v[40:43], v[124:127]
    ds_read_b128 v[188:191], v12 offset:49152
    ds_read_b128 v[204:207], v12 offset:53248
    v_add_f32 v21, v21, v64
    v_add_f32 v28, v28, v65
    s_waitcnt lgkmcnt(9)
    v_mfma_f32_16x16x32_bf16 v[120:123], v[220:223], v[44:47], v[120:123]
    s_add_u32 m0, s100, 81920
    s_mov_b32 s61, 114688
    buffer_load_dwordx4 v4, s[20:23], s61 offen offset:1024 nt lds
    v_cvt_pk_bf16_f32 v64, v64, v65
    v_add_f32 v21, v21, v66
    s_waitcnt lgkmcnt(8)
    v_mfma_f32_16x16x32_bf16 v[124:127], v[236:239], v[44:47], v[124:127]
    v_add_f32 v28, v28, v67
    v_cvt_pk_bf16_f32 v65, v66, v67
    s_waitcnt lgkmcnt(7)
    v_mfma_f32_16x16x32_bf16 v[128:131], v[176:179], v[32:35], 0
    ds_read_b128 v[208:211], v9 offset:57344
    v_max3_f32 v24, v112, v113, v114
    v_max3_f32 v24, v24, v115, v116
    s_waitcnt lgkmcnt(7)
    v_mfma_f32_16x16x32_bf16 v[132:135], v[192:195], v[32:35], 0
    ds_read_b128 v[224:227], v9 offset:61440
    v_max3_f32 v24, v24, v117, v118
    v_max3_f32 v24, v24, v119, v120
    v_max3_f32 v24, v24, v121, v122
    s_waitcnt lgkmcnt(7)
    v_mfma_f32_16x16x32_bf16 v[128:131], v[180:183], v[36:39], v[128:131]
    ds_read_b128 v[212:215], v10 offset:57344
    ds_read_b128 v[228:231], v10 offset:61440
    v_max3_f32 v24, v24, v123, v124
    v_max3_f32 v24, v24, v125, v126
    s_waitcnt lgkmcnt(8)
    v_mfma_f32_16x16x32_bf16 v[132:135], v[196:199], v[36:39], v[132:135]
    ds_read_b128 v[216:219], v11 offset:57344
    v_max_f32 v24, v24, v127
    v_add_f32 v21, v21, v68
    v_add_f32 v28, v28, v69
    s_waitcnt lgkmcnt(8)
    v_mfma_f32_16x16x32_bf16 v[128:131], v[184:187], v[40:43], v[128:131]
    ds_read_b128 v[232:235], v11 offset:61440
    v_cvt_pk_bf16_f32 v66, v68, v69
    v_add_f32 v21, v21, v70
    v_add_f32 v28, v28, v71
    s_waitcnt lgkmcnt(8)
    v_mfma_f32_16x16x32_bf16 v[132:135], v[200:203], v[40:43], v[132:135]
    ds_read_b128 v[220:223], v12 offset:57344
    ds_read_b128 v[236:239], v12 offset:61440
    v_cvt_pk_bf16_f32 v67, v70, v71
    v_pk_fma_f32 v[72:73], v[72:73], s[56:57], v[0:1] op_sel_hi:[1,0,0] neg_lo:[0,0,1] neg_hi:[0,0,1]
    s_waitcnt lgkmcnt(9)
    v_mfma_f32_16x16x32_bf16 v[128:131], v[188:191], v[44:47], v[128:131]
    s_waitcnt vmcnt(3)
    s_add_u32 m0, s100, 98304
    s_mov_b32 s61, 0
    buffer_load_dwordx4 v5, s[24:27], s61 offen nt lds
    v_pk_fma_f32 v[74:75], v[74:75], s[56:57], v[0:1] op_sel_hi:[1,0,0] neg_lo:[0,0,1] neg_hi:[0,0,1]
    v_pk_fma_f32 v[76:77], v[76:77], s[56:57], v[0:1] op_sel_hi:[1,0,0] neg_lo:[0,0,1] neg_hi:[0,0,1]
    v_pk_fma_f32 v[78:79], v[78:79], s[56:57], v[0:1] op_sel_hi:[1,0,0] neg_lo:[0,0,1] neg_hi:[0,0,1]
    s_waitcnt lgkmcnt(8)
    v_mfma_f32_16x16x32_bf16 v[132:135], v[204:207], v[44:47], v[132:135]
    v_exp_f32 v72, v72
    v_exp_f32 v73, v73
    v_exp_f32 v74, v74
    s_waitcnt vmcnt(3)
    s_barrier
    s_waitcnt lgkmcnt(7)
    v_mfma_f32_16x16x32_bf16 v[136:139], v[208:211], v[32:35], 0
    v_add_u32 v9, 65536, v9
    v_add_u32 v10, 65536, v10
    v_exp_f32 v75, v75
    v_exp_f32 v76, v76
    s_waitcnt lgkmcnt(6)
    v_mfma_f32_16x16x32_bf16 v[140:143], v[224:227], v[32:35], 0
    v_add_u32 v11, 65536, v11
    v_add_u32 v12, 65536, v12
    v_exp_f32 v77, v77
    v_exp_f32 v78, v78
    v_exp_f32 v79, v79
    s_waitcnt lgkmcnt(5)
    v_mfma_f32_16x16x32_bf16 v[136:139], v[212:215], v[36:39], v[136:139]
    ds_read_b128 v[176:179], v9 offset:0
    ds_read_b128 v[192:195], v9 offset:4096
    v_add_f32 v21, v21, v72
    v_add_f32 v28, v28, v73
    s_waitcnt lgkmcnt(6)
    v_mfma_f32_16x16x32_bf16 v[140:143], v[228:231], v[36:39], v[140:143]
    ds_read_b128 v[180:183], v10 offset:0
    ds_read_b128 v[196:199], v10 offset:4096
    v_cvt_pk_bf16_f32 v68, v72, v73
    v_add_f32 v21, v21, v74
    v_add_f32 v28, v28, v75
    s_waitcnt lgkmcnt(7)
    v_mfma_f32_16x16x32_bf16 v[136:139], v[216:219], v[40:43], v[136:139]
    ds_read_b128 v[184:187], v11 offset:0
    ds_read_b128 v[200:203], v11 offset:4096
    v_cvt_pk_bf16_f32 v69, v74, v75
    v_add_f32 v21, v21, v76
    v_add_f32 v28, v28, v77
    s_waitcnt lgkmcnt(8)
    v_mfma_f32_16x16x32_bf16 v[140:143], v[232:235], v[40:43], v[140:143]
    ds_read_b128 v[188:191], v12 offset:0
    ds_read_b128 v[204:207], v12 offset:4096
    v_cvt_pk_bf16_f32 v70, v76, v77
    v_add_f32 v21, v21, v78
    s_waitcnt lgkmcnt(9)
    v_mfma_f32_16x16x32_bf16 v[136:139], v[220:223], v[44:47], v[136:139]
    s_add_u32 m0, s100, 98304
    s_mov_b32 s61, 0
    buffer_load_dwordx4 v6, s[24:27], s61 offen offset:1024 nt lds
    v_add_f32 v28, v28, v79
    v_cvt_pk_bf16_f32 v71, v78, v79
    v_mul_f32 v21, v21, v26
    s_waitcnt lgkmcnt(8)
    v_mfma_f32_16x16x32_bf16 v[140:143], v[236:239], v[44:47], v[140:143]
    v_mul_f32 v28, v28, v26
    v_pk_fma_f32 v[80:81], v[80:81], s[56:57], v[22:23] op_sel_hi:[1,0,0] neg_lo:[0,0,1] neg_hi:[0,0,1]
    v_pk_fma_f32 v[82:83], v[82:83], s[56:57], v[22:23] op_sel_hi:[1,0,0] neg_lo:[0,0,1] neg_hi:[0,0,1]
    s_waitcnt lgkmcnt(7)
    v_mfma_f32_16x16x32_bf16 v[144:147], v[176:179], v[32:35], 0
    ds_read_b128 v[208:211], v9 offset:8192
    v_max3_f32 v24, v24, v128, v129
    v_max3_f32 v24, v24, v130, v131
    s_waitcnt lgkmcnt(7)
    v_mfma_f32_16x16x32_bf16 v[148:151], v[192:195], v[32:35], 0
    ds_read_b128 v[224:227], v9 offset:12288
    v_max3_f32 v24, v24, v132, v133
    v_max3_f32 v24, v24, v134, v135
    s_waitcnt lgkmcnt(7)
    v_mfma_f32_16x16x32_bf16 v[144:147], v[180:183], v[36:39], v[144:147]
    ds_read_b128 v[212:215], v10 offset:8192
    ds_read_b128 v[228:231], v10 offset:12288
    v_max3_f32 v24, v24, v136, v137
    v_max3_f32 v24, v24, v138, v139
    s_waitcnt lgkmcnt(8)
    v_mfma_f32_16x16x32_bf16 v[148:151], v[196:199], v[36:39], v[148:151]
    ds_read_b128 v[216:219], v11 offset:8192
    v_max3_f32 v24, v24, v140, v141
    v_max3_f32 v24, v24, v142, v143
    s_waitcnt lgkmcnt(8)
    v_mfma_f32_16x16x32_bf16 v[144:147], v[184:187], v[40:43], v[144:147]
    ds_read_b128 v[232:235], v11 offset:12288
    v_pk_fma_f32 v[84:85], v[84:85], s[56:57], v[22:23] op_sel_hi:[1,0,0] neg_lo:[0,0,1] neg_hi:[0,0,1]
    v_pk_fma_f32 v[86:87], v[86:87], s[56:57], v[22:23] op_sel_hi:[1,0,0] neg_lo:[0,0,1] neg_hi:[0,0,1]
    s_waitcnt lgkmcnt(8)
    v_mfma_f32_16x16x32_bf16 v[148:151], v[200:203], v[40:43], v[148:151]
    ds_read_b128 v[220:223], v12 offset:8192
    ds_read_b128 v[236:239], v12 offset:12288
    v_exp_f32 v80, v80
    v_exp_f32 v81, v81
    s_waitcnt lgkmcnt(9)
    v_mfma_f32_16x16x32_bf16 v[144:147], v[188:191], v[44:47], v[144:147]
    s_waitcnt vmcnt(3)
    s_add_u32 m0, s100, 114688
    s_mov_b32 s61, 16384
    buffer_load_dwordx4 v5, s[24:27], s61 offen nt lds
    v_exp_f32 v82, v82
    v_exp_f32 v83, v83
    s_waitcnt lgkmcnt(8)
    v_mfma_f32_16x16x32_bf16 v[148:151], v[204:207], v[44:47], v[148:151]
    v_exp_f32 v84, v84
    v_exp_f32 v85, v85
    s_waitcnt vmcnt(3)
    s_barrier
    s_waitcnt lgkmcnt(7)
    v_mfma_f32_16x16x32_bf16 v[152:155], v[208:211], v[32:35], 0
    ds_read_b128 v[176:179], v9 offset:16384
    v_exp_f32 v86, v86
    v_exp_f32 v87, v87
    s_waitcnt lgkmcnt(7)
    v_mfma_f32_16x16x32_bf16 v[156:159], v[224:227], v[32:35], 0
    ds_read_b128 v[192:195], v9 offset:20480
    v_add_f32 v21, v21, v80
    v_add_f32 v28, v28, v81
    v_cvt_pk_bf16_f32 v80, v80, v81
    s_waitcnt lgkmcnt(7)
    v_mfma_f32_16x16x32_bf16 v[152:155], v[212:215], v[36:39], v[152:155]
    ds_read_b128 v[180:183], v10 offset:16384
    ds_read_b128 v[196:199], v10 offset:20480
    v_add_f32 v21, v21, v82
    v_add_f32 v28, v28, v83
    s_waitcnt lgkmcnt(8)
    v_mfma_f32_16x16x32_bf16 v[156:159], v[228:231], v[36:39], v[156:159]
    ds_read_b128 v[184:187], v11 offset:16384
    v_cvt_pk_bf16_f32 v81, v82, v83
    v_add_f32 v21, v21, v84
    v_add_f32 v28, v28, v85
    s_waitcnt lgkmcnt(8)
    v_mfma_f32_16x16x32_bf16 v[152:155], v[216:219], v[40:43], v[152:155]
    ds_read_b128 v[200:203], v11 offset:20480
    v_cvt_pk_bf16_f32 v82, v84, v85
    v_add_f32 v21, v21, v86
    v_add_f32 v28, v28, v87
    s_waitcnt lgkmcnt(8)
    v_mfma_f32_16x16x32_bf16 v[156:159], v[232:235], v[40:43], v[156:159]
    ds_read_b128 v[188:191], v12 offset:16384
    ds_read_b128 v[204:207], v12 offset:20480
    v_cvt_pk_bf16_f32 v83, v86, v87
    v_pk_fma_f32 v[88:89], v[88:89], s[56:57], v[22:23] op_sel_hi:[1,0,0] neg_lo:[0,0,1] neg_hi:[0,0,1]
    s_waitcnt lgkmcnt(9)
    v_mfma_f32_16x16x32_bf16 v[152:155], v[220:223], v[44:47], v[152:155]
    s_add_u32 m0, s100, 114688
    s_mov_b32 s61, 16384
    buffer_load_dwordx4 v6, s[24:27], s61 offen offset:1024 nt lds
    v_pk_fma_f32 v[90:91], v[90:91], s[56:57], v[22:23] op_sel_hi:[1,0,0] neg_lo:[0,0,1] neg_hi:[0,0,1]
    v_pk_fma_f32 v[92:93], v[92:93], s[56:57], v[22:23] op_sel_hi:[1,0,0] neg_lo:[0,0,1] neg_hi:[0,0,1]
    v_pk_fma_f32 v[94:95], v[94:95], s[56:57], v[22:23] op_sel_hi:[1,0,0] neg_lo:[0,0,1] neg_hi:[0,0,1]
    s_waitcnt lgkmcnt(8)
    v_mfma_f32_16x16x32_bf16 v[156:159], v[236:239], v[44:47], v[156:159]
    v_exp_f32 v88, v88
    v_exp_f32 v89, v89
    v_exp_f32 v90, v90
    s_waitcnt lgkmcnt(7)
    v_mfma_f32_16x16x32_bf16 v[160:163], v[176:179], v[32:35], 0
    ds_read_b128 v[208:211], v9 offset:24576
    v_max3_f32 v24, v24, v144, v145
    v_max3_f32 v24, v24, v146, v147
    s_waitcnt lgkmcnt(7)
    v_mfma_f32_16x16x32_bf16 v[164:167], v[192:195], v[32:35], 0
    ds_read_b128 v[224:227], v9 offset:28672
    v_max3_f32 v24, v24, v148, v149
    v_max3_f32 v24, v24, v150, v151
    s_waitcnt lgkmcnt(7)
    v_mfma_f32_16x16x32_bf16 v[160:163], v[180:183], v[36:39], v[160:163]
    ds_read_b128 v[212:215], v10 offset:24576
    ds_read_b128 v[228:231], v10 offset:28672
    v_max3_f32 v24, v24, v152, v153
    v_max3_f32 v24, v24, v154, v155
    s_waitcnt lgkmcnt(8)
    v_mfma_f32_16x16x32_bf16 v[164:167], v[196:199], v[36:39], v[164:167]
    ds_read_b128 v[216:219], v11 offset:24576
    v_max3_f32 v24, v24, v156, v157
    v_max3_f32 v24, v24, v158, v159
    v_exp_f32 v91, v91
    s_waitcnt lgkmcnt(8)
    v_mfma_f32_16x16x32_bf16 v[160:163], v[184:187], v[40:43], v[160:163]
    ds_read_b128 v[232:235], v11 offset:28672
    v_exp_f32 v92, v92
    v_exp_f32 v93, v93
    s_waitcnt lgkmcnt(8)
    v_mfma_f32_16x16x32_bf16 v[164:167], v[200:203], v[40:43], v[164:167]
    ds_read_b128 v[220:223], v12 offset:24576
    ds_read_b128 v[236:239], v12 offset:28672
    v_exp_f32 v94, v94
    v_exp_f32 v95, v95
    s_waitcnt lgkmcnt(9)
    v_mfma_f32_16x16x32_bf16 v[160:163], v[188:191], v[44:47], v[160:163]
    s_waitcnt vmcnt(3)
    s_add_u32 m0, s100, 131072
    s_mov_b32 s61, 32768
    buffer_load_dwordx4 v5, s[24:27], s61 offen nt lds
    v_add_f32 v21, v21, v88
    v_add_f32 v28, v28, v89
    s_waitcnt lgkmcnt(8)
    v_mfma_f32_16x16x32_bf16 v[164:167], v[204:207], v[44:47], v[164:167]
    v_cvt_pk_bf16_f32 v84, v88, v89
    v_add_f32 v21, v21, v90
    v_add_f32 v28, v28, v91
    s_waitcnt vmcnt(3)
    s_barrier
    s_waitcnt lgkmcnt(7)
    v_mfma_f32_16x16x32_bf16 v[168:171], v[208:211], v[32:35], 0
    v_add_u32 v13, 65536, v13
    v_add_u32 v14, 65536, v14
    v_add_u32 v15, 65536, v15
    v_add_u32 v16, 65536, v16
    v_cvt_pk_bf16_f32 v85, v90, v91
    v_add_f32 v21, v21, v92
    s_waitcnt lgkmcnt(6)
    v_mfma_f32_16x16x32_bf16 v[172:175], v[224:227], v[32:35], 0
    v_add_u32 v17, 65536, v17
    v_add_u32 v18, 65536, v18
    v_add_u32 v19, 65536, v19
    v_add_u32 v20, 65536, v20
    v_add_f32 v28, v28, v93
    v_cvt_pk_bf16_f32 v86, v92, v93
    s_waitcnt lgkmcnt(5)
    v_mfma_f32_16x16x32_bf16 v[168:171], v[212:215], v[36:39], v[168:171]
    ds_read_b64_tr_b16 v[176:177], v13 offset:32768
    ds_read_b64_tr_b16 v[178:179], v13 offset:36864
    ds_read_b64_tr_b16 v[180:181], v14 offset:32768
    ds_read_b64_tr_b16 v[182:183], v14 offset:36864
    v_add_f32 v21, v21, v94
    v_add_f32 v28, v28, v95
    s_waitcnt lgkmcnt(8)
    v_mfma_f32_16x16x32_bf16 v[172:175], v[228:231], v[36:39], v[172:175]
    ds_read_b64_tr_b16 v[184:185], v15 offset:32768
    ds_read_b64_tr_b16 v[186:187], v15 offset:36864
    ds_read_b64_tr_b16 v[188:189], v16 offset:32768
    ds_read_b64_tr_b16 v[190:191], v16 offset:36864
    v_cvt_pk_bf16_f32 v87, v94, v95
    v_pk_fma_f32 v[96:97], v[96:97], s[56:57], v[22:23] op_sel_hi:[1,0,0] neg_lo:[0,0,1] neg_hi:[0,0,1]
    s_waitcnt lgkmcnt(11)
    v_mfma_f32_16x16x32_bf16 v[168:171], v[216:219], v[40:43], v[168:171]
    ds_read_b64_tr_b16 v[192:193], v17 offset:32768
    ds_read_b64_tr_b16 v[194:195], v17 offset:36864
    ds_read_b64_tr_b16 v[196:197], v18 offset:32768
    ds_read_b64_tr_b16 v[198:199], v18 offset:36864
    v_pk_fma_f32 v[98:99], v[98:99], s[56:57], v[22:23] op_sel_hi:[1,0,0] neg_lo:[0,0,1] neg_hi:[0,0,1]
    v_pk_fma_f32 v[100:101], v[100:101], s[56:57], v[22:23] op_sel_hi:[1,0,0] neg_lo:[0,0,1] neg_hi:[0,0,1]
    s_waitcnt lgkmcnt(14)
    v_mfma_f32_16x16x32_bf16 v[172:175], v[232:235], v[40:43], v[172:175]
    ds_read_b64_tr_b16 v[200:201], v19 offset:32768
    ds_read_b64_tr_b16 v[202:203], v19 offset:36864
    ds_read_b64_tr_b16 v[204:205], v20 offset:32768
    ds_read_b64_tr_b16 v[206:207], v20 offset:36864
    v_pk_fma_f32 v[102:103], v[102:103], s[56:57], v[22:23] op_sel_hi:[1,0,0] neg_lo:[0,0,1] neg_hi:[0,0,1]
    v_exp_f32 v96, v96
    s_waitcnt lgkmcnt(15)
    v_mfma_f32_16x16x32_bf16 v[168:171], v[220:223], v[44:47], v[168:171]
    s_add_u32 m0, s100, 131072
    s_mov_b32 s61, 32768
    buffer_load_dwordx4 v6, s[24:27], s61 offen offset:1024 nt lds
    s_add_u32 m0, s100, 65536
    s_mov_b32 s61, 0
    buffer_load_dwordx4 v7, s[36:39], s61 offen lds
    s_add_u32 m0, s100, 65536
    s_mov_b32 s61, 0
    buffer_load_dwordx4 v8, s[36:39], s61 offen offset:1024 lds
    v_exp_f32 v97, v97
    v_exp_f32 v98, v98
    v_mfma_f32_16x16x32_bf16 v[172:175], v[236:239], v[44:47], v[172:175]
    v_exp_f32 v99, v99
    v_exp_f32 v100, v100
    v_exp_f32 v101, v101
    s_barrier
    s_waitcnt lgkmcnt(14)
    v_mfma_f32_16x16x32_bf16 v[32:35], v[176:179], v[48:51], 0
    ds_read_b64_tr_b16 v[208:209], v13 offset:40960
    ds_read_b64_tr_b16 v[210:211], v13 offset:45056
    v_max3_f32 v24, v24, v160, v161
    v_max3_f32 v24, v24, v162, v163
    s_waitcnt lgkmcnt(14)
    v_mfma_f32_16x16x32_bf16 v[36:39], v[180:183], v[48:51], 0
    ds_read_b64_tr_b16 v[212:213], v14 offset:40960
    ds_read_b64_tr_b16 v[214:215], v14 offset:45056
    ds_read_b64_tr_b16 v[216:217], v15 offset:40960
    v_max3_f32 v24, v24, v164, v165
    v_max3_f32 v24, v24, v166, v167
    v_max3_f32 v24, v24, v168, v169
    s_waitcnt lgkmcnt(15)
    v_mfma_f32_16x16x32_bf16 v[40:43], v[184:187], v[48:51], 0
    ds_read_b64_tr_b16 v[218:219], v15 offset:45056
    ds_read_b64_tr_b16 v[220:221], v16 offset:40960
    ds_read_b64_tr_b16 v[222:223], v16 offset:45056
    v_max3_f32 v24, v24, v170, v171
    v_max3_f32 v24, v24, v172, v173
    v_max3_f32 v24, v24, v174, v175
    s_waitcnt lgkmcnt(15)
    v_mfma_f32_16x16x32_bf16 v[44:47], v[188:191], v[48:51], 0
    ds_read_b64_tr_b16 v[224:225], v17 offset:40960
    ds_read_b64_tr_b16 v[226:227], v17 offset:45056
    v_mov_b32 v23, v24
    s_nop 1
    v_permlane32_swap_b32 v24, v23
    s_waitcnt lgkmcnt(15)
    v_mfma_f32_16x16x32_bf16 v[240:243], v[192:195], v[48:51], 0
    ds_read_b64_tr_b16 v[228:229], v18 offset:40960
    ds_read_b64_tr_b16 v[230:231], v18 offset:45056
    ds_read_b64_tr_b16 v[232:233], v19 offset:40960
    s_nop 0
    v_max_f32 v24, v24, v23
    v_mov_b32 v23, v24
    s_waitcnt lgkmcnt(15)
    v_mfma_f32_16x16x32_bf16 v[244:247], v[196:199], v[48:51], 0
    ds_read_b64_tr_b16 v[234:235], v19 offset:45056
    ds_read_b64_tr_b16 v[236:237], v20 offset:40960
    ds_read_b64_tr_b16 v[238:239], v20 offset:45056
    s_nop 1
    v_permlane16_swap_b32 v24, v23
    s_nop 0
    v_mfma_f32_16x16x32_bf16 v[248:251], v[200:203], v[48:51], 0
    s_waitcnt vmcnt(5)
    s_add_u32 m0, s100, 147456
    s_mov_b32 s61, 49152
    buffer_load_dwordx4 v5, s[24:27], s61 offen nt lds
    s_add_u32 m0, s100, 81920
    s_mov_b32 s61, 65536
    buffer_load_dwordx4 v7, s[36:39], s61 offen lds
    s_add_u32 m0, s100, 81920
    s_mov_b32 s61, 65536
    buffer_load_dwordx4 v8, s[36:39], s61 offen offset:1024 lds
    v_max_f32 v24, v24, v23
    v_mul_f32 v24, s56, v24
    v_max_f32 v24, v24, v22
    s_waitcnt lgkmcnt(15)
    v_mfma_f32_16x16x32_bf16 v[252:255], v[204:207], v[48:51], 0
    v_sub_f32 v27, v22, v24
    v_exp_f32 v27, v27
    v_exp_f32 v102, v102
    s_waitcnt vmcnt(7)
    s_barrier
    s_waitcnt lgkmcnt(14)
    v_mfma_f32_16x16x32_bf16 v[32:35], v[208:211], v[52:55], v[32:35]
    ds_read_b64_tr_b16 v[176:177], v13 offset:49152
    ds_read_b64_tr_b16 v[178:179], v13 offset:53248
    v_exp_f32 v103, v103
    v_add_f32 v21, v21, v96
    s_waitcnt lgkmcnt(14)
    v_mfma_f32_16x16x32_bf16 v[36:39], v[212:215], v[52:55], v[36:39]
    ds_read_b64_tr_b16 v[180:181], v14 offset:49152
    ds_read_b64_tr_b16 v[182:183], v14 offset:53248
    ds_read_b64_tr_b16 v[184:185], v15 offset:49152
    v_add_f32 v28, v28, v97
    v_cvt_pk_bf16_f32 v96, v96, v97
    v_add_f32 v21, v21, v98
    s_waitcnt lgkmcnt(15)
    v_mfma_f32_16x16x32_bf16 v[40:43], v[216:219], v[52:55], v[40:43]
    ds_read_b64_tr_b16 v[186:187], v15 offset:53248
    ds_read_b64_tr_b16 v[188:189], v16 offset:49152
    ds_read_b64_tr_b16 v[190:191], v16 offset:53248
    v_add_f32 v28, v28, v99
    v_cvt_pk_bf16_f32 v97, v98, v99
    s_waitcnt lgkmcnt(15)
    v_mfma_f32_16x16x32_bf16 v[44:47], v[220:223], v[52:55], v[44:47]
    ds_read_b64_tr_b16 v[192:193], v17 offset:49152
    ds_read_b64_tr_b16 v[194:195], v17 offset:53248
    v_add_f32 v21, v21, v100
    v_add_f32 v28, v28, v101
    v_cvt_pk_bf16_f32 v98, v100, v101
    s_waitcnt lgkmcnt(15)
    v_mfma_f32_16x16x32_bf16 v[240:243], v[224:227], v[52:55], v[240:243]
    ds_read_b64_tr_b16 v[196:197], v18 offset:49152
    ds_read_b64_tr_b16 v[198:199], v18 offset:53248
    ds_read_b64_tr_b16 v[200:201], v19 offset:49152
    v_add_f32 v21, v21, v102
    v_add_f32 v28, v28, v103
    v_cvt_pk_bf16_f32 v99, v102, v103
    s_waitcnt lgkmcnt(15)
    v_mfma_f32_16x16x32_bf16 v[244:247], v[228:231], v[52:55], v[244:247]
    ds_read_b64_tr_b16 v[202:203], v19 offset:53248
    ds_read_b64_tr_b16 v[204:205], v20 offset:49152
    ds_read_b64_tr_b16 v[206:207], v20 offset:53248
    v_pk_fma_f32 v[104:105], v[104:105], s[56:57], v[22:23] op_sel_hi:[1,0,0] neg_lo:[0,0,1] neg_hi:[0,0,1]
    v_pk_fma_f32 v[106:107], v[106:107], s[56:57], v[22:23] op_sel_hi:[1,0,0] neg_lo:[0,0,1] neg_hi:[0,0,1]
    v_mfma_f32_16x16x32_bf16 v[248:251], v[232:235], v[52:55], v[248:251]
    s_add_u32 m0, s100, 147456
    s_mov_b32 s61, 49152
    buffer_load_dwordx4 v6, s[24:27], s61 offen offset:1024 nt lds
    v_pk_fma_f32 v[108:109], v[108:109], s[56:57], v[22:23] op_sel_hi:[1,0,0] neg_lo:[0,0,1] neg_hi:[0,0,1]
    v_pk_fma_f32 v[110:111], v[110:111], s[56:57], v[22:23] op_sel_hi:[1,0,0] neg_lo:[0,0,1] neg_hi:[0,0,1]
    v_exp_f32 v104, v104
    s_waitcnt lgkmcnt(15)
    v_mfma_f32_16x16x32_bf16 v[252:255], v[236:239], v[52:55], v[252:255]
    v_exp_f32 v105, v105
    v_exp_f32 v106, v106
    v_exp_f32 v107, v107
    s_waitcnt lgkmcnt(14)
    v_mfma_f32_16x16x32_bf16 v[32:35], v[176:179], v[64:67], v[32:35]
    ds_read_b64_tr_b16 v[208:209], v13 offset:57344
    ds_read_b64_tr_b16 v[210:211], v13 offset:61440
    v_exp_f32 v108, v108
    v_exp_f32 v109, v109
    s_waitcnt lgkmcnt(14)
    v_mfma_f32_16x16x32_bf16 v[36:39], v[180:183], v[64:67], v[36:39]
    ds_read_b64_tr_b16 v[212:213], v14 offset:57344
    ds_read_b64_tr_b16 v[214:215], v14 offset:61440
    ds_read_b64_tr_b16 v[216:217], v15 offset:57344
    v_exp_f32 v110, v110
    v_exp_f32 v111, v111
    v_add_f32 v21, v21, v104
    s_waitcnt lgkmcnt(15)
    v_mfma_f32_16x16x32_bf16 v[40:43], v[184:187], v[64:67], v[40:43]
    ds_read_b64_tr_b16 v[218:219], v15 offset:61440
    ds_read_b64_tr_b16 v[220:221], v16 offset:57344
    ds_read_b64_tr_b16 v[222:223], v16 offset:61440
    v_add_f32 v28, v28, v105
    v_cvt_pk_bf16_f32 v100, v104, v105
    v_add_f32 v21, v21, v106
    s_waitcnt lgkmcnt(15)
    v_mfma_f32_16x16x32_bf16 v[44:47], v[188:191], v[64:67], v[44:47]
    ds_read_b64_tr_b16 v[224:225], v17 offset:57344
    ds_read_b64_tr_b16 v[226:227], v17 offset:61440
    v_add_f32 v28, v28, v107
    v_cvt_pk_bf16_f32 v101, v106, v107
    v_add_f32 v21, v21, v108
    s_waitcnt lgkmcnt(15)
    v_mfma_f32_16x16x32_bf16 v[240:243], v[192:195], v[64:67], v[240:243]
    ds_read_b64_tr_b16 v[228:229], v18 offset:57344
    ds_read_b64_tr_b16 v[230:231], v18 offset:61440
    ds_read_b64_tr_b16 v[232:233], v19 offset:57344
    v_add_f32 v28, v28, v109
    v_cvt_pk_bf16_f32 v102, v108, v109
    s_waitcnt lgkmcnt(15)
    v_mfma_f32_16x16x32_bf16 v[244:247], v[196:199], v[64:67], v[244:247]
    ds_read_b64_tr_b16 v[234:235], v19 offset:61440
    ds_read_b64_tr_b16 v[236:237], v20 offset:57344
    ds_read_b64_tr_b16 v[238:239], v20 offset:61440
    v_add_f32 v21, v21, v110
    v_add_f32 v28, v28, v111
    v_cvt_pk_bf16_f32 v103, v110, v111
    v_mfma_f32_16x16x32_bf16 v[248:251], v[200:203], v[64:67], v[248:251]
    s_waitcnt vmcnt(7)
    s_add_u32 m0, s100, 0
    s_mov_b32 s61, 65536
    buffer_load_dwordx4 v5, s[24:27], s61 offen nt lds
    v_mul_f32 v21, v21, v27
    v_mul_f32 v28, v28, v27
    v_pk_fma_f32 v[112:113], v[112:113], s[56:57], v[24:25] op_sel_hi:[1,0,0] neg_lo:[0,0,1] neg_hi:[0,0,1]
    s_waitcnt lgkmcnt(15)
    v_mfma_f32_16x16x32_bf16 v[252:255], v[204:207], v[64:67], v[252:255]
    v_pk_fma_f32 v[114:115], v[114:115], s[56:57], v[24:25] op_sel_hi:[1,0,0] neg_lo:[0,0,1] neg_hi:[0,0,1]
    v_pk_fma_f32 v[116:117], v[116:117], s[56:57], v[24:25] op_sel_hi:[1,0,0] neg_lo:[0,0,1] neg_hi:[0,0,1]
    v_pk_fma_f32 v[118:119], v[118:119], s[56:57], v[24:25] op_sel_hi:[1,0,0] neg_lo:[0,0,1] neg_hi:[0,0,1]
    s_waitcnt vmcnt(7)
    s_barrier
    s_waitcnt lgkmcnt(14)
    v_mfma_f32_16x16x32_bf16 v[32:35], v[208:211], v[68:71], v[32:35]
    v_add_u32 v13, 65536, v13
    v_add_u32 v14, 65536, v14
    v_add_u32 v15, 65536, v15
    v_add_u32 v16, 65536, v16
    v_exp_f32 v112, v112
    v_exp_f32 v113, v113
    s_waitcnt lgkmcnt(12)
    v_mfma_f32_16x16x32_bf16 v[36:39], v[212:215], v[68:71], v[36:39]
    v_add_u32 v17, 65536, v17
    v_add_u32 v18, 65536, v18
    v_add_u32 v19, 65536, v19
    v_add_u32 v20, 65536, v20
    v_exp_f32 v114, v114
    v_exp_f32 v115, v115
    s_waitcnt lgkmcnt(10)
    v_mfma_f32_16x16x32_bf16 v[40:43], v[216:219], v[68:71], v[40:43]
    ds_read_b64_tr_b16 v[176:177], v13 offset:0
    ds_read_b64_tr_b16 v[178:179], v13 offset:4096
    ds_read_b64_tr_b16 v[180:181], v14 offset:0
    ds_read_b64_tr_b16 v[182:183], v14 offset:4096
    v_exp_f32 v116, v116
    v_exp_f32 v117, v117
    s_waitcnt lgkmcnt(12)
    v_mfma_f32_16x16x32_bf16 v[44:47], v[220:223], v[68:71], v[44:47]
    ds_read_b64_tr_b16 v[184:185], v15 offset:0
    ds_read_b64_tr_b16 v[186:187], v15 offset:4096
    ds_read_b64_tr_b16 v[188:189], v16 offset:0
    ds_read_b64_tr_b16 v[190:191], v16 offset:4096
    v_exp_f32 v118, v118
    v_exp_f32 v119, v119
    s_waitcnt lgkmcnt(14)
    v_mfma_f32_16x16x32_bf16 v[240:243], v[224:227], v[68:71], v[240:243]
    ds_read_b64_tr_b16 v[192:193], v17 offset:0
    ds_read_b64_tr_b16 v[194:195], v17 offset:4096
    ds_read_b64_tr_b16 v[196:197], v18 offset:0
    ds_read_b64_tr_b16 v[198:199], v18 offset:4096
    v_add_f32 v21, v21, v112
    v_add_f32 v28, v28, v113
    s_waitcnt lgkmcnt(15)
    v_mfma_f32_16x16x32_bf16 v[244:247], v[228:231], v[68:71], v[244:247]
    ds_read_b64_tr_b16 v[200:201], v19 offset:0
    ds_read_b64_tr_b16 v[202:203], v19 offset:4096
    ds_read_b64_tr_b16 v[204:205], v20 offset:0
    ds_read_b64_tr_b16 v[206:207], v20 offset:4096
    v_cvt_pk_bf16_f32 v112, v112, v113
    v_add_f32 v21, v21, v114
    s_waitcnt lgkmcnt(15)
    v_mfma_f32_16x16x32_bf16 v[248:251], v[232:235], v[68:71], v[248:251]
    s_add_u32 m0, s100, 0
    s_mov_b32 s61, 65536
    buffer_load_dwordx4 v6, s[24:27], s61 offen offset:1024 nt lds
    s_add_u32 m0, s100, 98304
    s_mov_b32 s61, 131072
    buffer_load_dwordx4 v7, s[36:39], s61 offen lds
    s_add_u32 m0, s100, 98304
    s_mov_b32 s61, 131072
    buffer_load_dwordx4 v8, s[36:39], s61 offen offset:1024 lds
    v_add_f32 v28, v28, v115
    v_cvt_pk_bf16_f32 v113, v114, v115
    v_mfma_f32_16x16x32_bf16 v[252:255], v[236:239], v[68:71], v[252:255]
    v_add_f32 v21, v21, v116
    v_add_f32 v28, v28, v117
    v_cvt_pk_bf16_f32 v114, v116, v117
    v_pk_mul_f32 v[32:33], v[32:33], v[26:27] op_sel_hi:[1,0]
    v_pk_mul_f32 v[34:35], v[34:35], v[26:27] op_sel_hi:[1,0]
    v_pk_mul_f32 v[36:37], v[36:37], v[26:27] op_sel_hi:[1,0]
    v_pk_mul_f32 v[38:39], v[38:39], v[26:27] op_sel_hi:[1,0]
    v_pk_mul_f32 v[40:41], v[40:41], v[26:27] op_sel_hi:[1,0]
    v_pk_mul_f32 v[42:43], v[42:43], v[26:27] op_sel_hi:[1,0]
    v_pk_mul_f32 v[44:45], v[44:45], v[26:27] op_sel_hi:[1,0]
    v_pk_mul_f32 v[46:47], v[46:47], v[26:27] op_sel_hi:[1,0]
    v_pk_mul_f32 v[240:241], v[240:241], v[26:27] op_sel_hi:[1,0]
    v_pk_mul_f32 v[242:243], v[242:243], v[26:27] op_sel_hi:[1,0]
    v_pk_mul_f32 v[244:245], v[244:245], v[26:27] op_sel_hi:[1,0]
    v_pk_mul_f32 v[246:247], v[246:247], v[26:27] op_sel_hi:[1,0]
    v_pk_mul_f32 v[248:249], v[248:249], v[26:27] op_sel_hi:[1,0]
    v_pk_mul_f32 v[250:251], v[250:251], v[26:27] op_sel_hi:[1,0]
    v_pk_mul_f32 v[252:253], v[252:253], v[26:27] op_sel_hi:[1,0]
    v_pk_mul_f32 v[254:255], v[254:255], v[26:27] op_sel_hi:[1,0]
    s_waitcnt lgkmcnt(14)
    v_mfma_f32_16x16x32_bf16 v[32:35], v[176:179], v[80:83], v[32:35]
    ds_read_b64_tr_b16 v[208:209], v13 offset:8192
    ds_read_b64_tr_b16 v[210:211], v13 offset:12288
    v_add_f32 v21, v21, v118
    s_waitcnt lgkmcnt(14)
    v_mfma_f32_16x16x32_bf16 v[36:39], v[180:183], v[80:83], v[36:39]
    ds_read_b64_tr_b16 v[212:213], v14 offset:8192
    ds_read_b64_tr_b16 v[214:215], v14 offset:12288
    ds_read_b64_tr_b16 v[216:217], v15 offset:8192
    v_add_f32 v28, v28, v119
    v_cvt_pk_bf16_f32 v115, v118, v119
    s_waitcnt lgkmcnt(15)
    v_mfma_f32_16x16x32_bf16 v[40:43], v[184:187], v[80:83], v[40:43]
    ds_read_b64_tr_b16 v[218:219], v15 offset:12288
    ds_read_b64_tr_b16 v[220:221], v16 offset:8192
    ds_read_b64_tr_b16 v[222:223], v16 offset:12288
    v_pk_fma_f32 v[120:121], v[120:121], s[56:57], v[24:25] op_sel_hi:[1,0,0] neg_lo:[0,0,1] neg_hi:[0,0,1]
    v_pk_fma_f32 v[122:123], v[122:123], s[56:57], v[24:25] op_sel_hi:[1,0,0] neg_lo:[0,0,1] neg_hi:[0,0,1]
    s_waitcnt lgkmcnt(15)
    v_mfma_f32_16x16x32_bf16 v[44:47], v[188:191], v[80:83], v[44:47]
    ds_read_b64_tr_b16 v[224:225], v17 offset:8192
    ds_read_b64_tr_b16 v[226:227], v17 offset:12288
    v_pk_fma_f32 v[124:125], v[124:125], s[56:57], v[24:25] op_sel_hi:[1,0,0] neg_lo:[0,0,1] neg_hi:[0,0,1]
    v_pk_fma_f32 v[126:127], v[126:127], s[56:57], v[24:25] op_sel_hi:[1,0,0] neg_lo:[0,0,1] neg_hi:[0,0,1]
    s_waitcnt lgkmcnt(15)
    v_mfma_f32_16x16x32_bf16 v[240:243], v[192:195], v[80:83], v[240:243]
    ds_read_b64_tr_b16 v[228:229], v18 offset:8192
    ds_read_b64_tr_b16 v[230:231], v18 offset:12288
    ds_read_b64_tr_b16 v[232:233], v19 offset:8192
    v_exp_f32 v120, v120
    v_exp_f32 v121, v121
    s_waitcnt lgkmcnt(15)
    v_mfma_f32_16x16x32_bf16 v[244:247], v[196:199], v[80:83], v[244:247]
    ds_read_b64_tr_b16 v[234:235], v19 offset:12288
    ds_read_b64_tr_b16 v[236:237], v20 offset:8192
    ds_read_b64_tr_b16 v[238:239], v20 offset:12288
    v_exp_f32 v122, v122
    v_exp_f32 v123, v123
    v_mfma_f32_16x16x32_bf16 v[248:251], v[200:203], v[80:83], v[248:251]
    s_waitcnt vmcnt(7)
    s_add_u32 m0, s100, 16384
    s_mov_b32 s61, 81920
    buffer_load_dwordx4 v5, s[24:27], s61 offen nt lds
    v_exp_f32 v124, v124
    v_exp_f32 v125, v125
    s_waitcnt lgkmcnt(15)
    v_mfma_f32_16x16x32_bf16 v[252:255], v[204:207], v[80:83], v[252:255]
    v_exp_f32 v126, v126
    v_exp_f32 v127, v127
    s_waitcnt vmcnt(5)
    s_barrier
    s_waitcnt lgkmcnt(14)
    v_mfma_f32_16x16x32_bf16 v[32:35], v[208:211], v[84:87], v[32:35]
    ds_read_b64_tr_b16 v[176:177], v13 offset:16384
    ds_read_b64_tr_b16 v[178:179], v13 offset:20480
    v_add_f32 v21, v21, v120
    v_add_f32 v28, v28, v121
    s_waitcnt lgkmcnt(14)
    v_mfma_f32_16x16x32_bf16 v[36:39], v[212:215], v[84:87], v[36:39]
    ds_read_b64_tr_b16 v[180:181], v14 offset:16384
    ds_read_b64_tr_b16 v[182:183], v14 offset:20480
    ds_read_b64_tr_b16 v[184:185], v15 offset:16384
    v_cvt_pk_bf16_f32 v116, v120, v121
    v_add_f32 v21, v21, v122
    v_add_f32 v28, v28, v123
    s_waitcnt lgkmcnt(15)
    v_mfma_f32_16x16x32_bf16 v[40:43], v[216:219], v[84:87], v[40:43]
    ds_read_b64_tr_b16 v[186:187], v15 offset:20480
    ds_read_b64_tr_b16 v[188:189], v16 offset:16384
    ds_read_b64_tr_b16 v[190:191], v16 offset:20480
    v_cvt_pk_bf16_f32 v117, v122, v123
    v_add_f32 v21, v21, v124
    s_waitcnt lgkmcnt(15)
    v_mfma_f32_16x16x32_bf16 v[44:47], v[220:223], v[84:87], v[44:47]
    ds_read_b64_tr_b16 v[192:193], v17 offset:16384
    ds_read_b64_tr_b16 v[194:195], v17 offset:20480
    v_add_f32 v28, v28, v125
    v_cvt_pk_bf16_f32 v118, v124, v125
    v_add_f32 v21, v21, v126
    s_waitcnt lgkmcnt(15)
    v_mfma_f32_16x16x32_bf16 v[240:243], v[224:227], v[84:87], v[240:243]
    ds_read_b64_tr_b16 v[196:197], v18 offset:16384
    ds_read_b64_tr_b16 v[198:199], v18 offset:20480
    ds_read_b64_tr_b16 v[200:201], v19 offset:16384
    v_add_f32 v28, v28, v127
    v_cvt_pk_bf16_f32 v119, v126, v127
    v_pk_fma_f32 v[128:129], v[128:129], s[56:57], v[24:25] op_sel_hi:[1,0,0] neg_lo:[0,0,1] neg_hi:[0,0,1]
    s_waitcnt lgkmcnt(15)
    v_mfma_f32_16x16x32_bf16 v[244:247], v[228:231], v[84:87], v[244:247]
    ds_read_b64_tr_b16 v[202:203], v19 offset:20480
    ds_read_b64_tr_b16 v[204:205], v20 offset:16384
    ds_read_b64_tr_b16 v[206:207], v20 offset:20480
    v_pk_fma_f32 v[130:131], v[130:131], s[56:57], v[24:25] op_sel_hi:[1,0,0] neg_lo:[0,0,1] neg_hi:[0,0,1]
    v_pk_fma_f32 v[132:133], v[132:133], s[56:57], v[24:25] op_sel_hi:[1,0,0] neg_lo:[0,0,1] neg_hi:[0,0,1]
    v_mfma_f32_16x16x32_bf16 v[248:251], v[232:235], v[84:87], v[248:251]
    s_add_u32 m0, s100, 16384
    s_mov_b32 s61, 81920
    buffer_load_dwordx4 v6, s[24:27], s61 offen offset:1024 nt lds
    s_add_u32 m0, s100, 114688
    s_mov_b32 s61, 196608
    buffer_load_dwordx4 v7, s[36:39], s61 offen lds
    s_add_u32 m0, s100, 114688
    s_mov_b32 s61, 196608
    buffer_load_dwordx4 v8, s[36:39], s61 offen offset:1024 lds
    v_pk_fma_f32 v[134:135], v[134:135], s[56:57], v[24:25] op_sel_hi:[1,0,0] neg_lo:[0,0,1] neg_hi:[0,0,1]
    v_exp_f32 v128, v128
    v_exp_f32 v129, v129
    s_waitcnt lgkmcnt(15)
    v_mfma_f32_16x16x32_bf16 v[252:255], v[236:239], v[84:87], v[252:255]
    v_exp_f32 v130, v130
    v_exp_f32 v131, v131
    v_exp_f32 v132, v132
    s_waitcnt lgkmcnt(14)
    v_mfma_f32_16x16x32_bf16 v[32:35], v[176:179], v[96:99], v[32:35]
    ds_read_b64_tr_b16 v[208:209], v13 offset:24576
    ds_read_b64_tr_b16 v[210:211], v13 offset:28672
    v_exp_f32 v133, v133
    v_exp_f32 v134, v134
    s_waitcnt lgkmcnt(14)
    v_mfma_f32_16x16x32_bf16 v[36:39], v[180:183], v[96:99], v[36:39]
    ds_read_b64_tr_b16 v[212:213], v14 offset:24576
    ds_read_b64_tr_b16 v[214:215], v14 offset:28672
    ds_read_b64_tr_b16 v[216:217], v15 offset:24576
    v_exp_f32 v135, v135
    v_add_f32 v21, v21, v128
    v_add_f32 v28, v28, v129
    s_waitcnt lgkmcnt(15)
    v_mfma_f32_16x16x32_bf16 v[40:43], v[184:187], v[96:99], v[40:43]
    ds_read_b64_tr_b16 v[218:219], v15 offset:28672
    ds_read_b64_tr_b16 v[220:221], v16 offset:24576
    ds_read_b64_tr_b16 v[222:223], v16 offset:28672
    v_cvt_pk_bf16_f32 v128, v128, v129
    v_add_f32 v21, v21, v130
    s_waitcnt lgkmcnt(15)
    v_mfma_f32_16x16x32_bf16 v[44:47], v[188:191], v[96:99], v[44:47]
    ds_read_b64_tr_b16 v[224:225], v17 offset:24576
    ds_read_b64_tr_b16 v[226:227], v17 offset:28672
    v_add_f32 v28, v28, v131
    v_cvt_pk_bf16_f32 v129, v130, v131
    v_add_f32 v21, v21, v132
    s_waitcnt lgkmcnt(15)
    v_mfma_f32_16x16x32_bf16 v[240:243], v[192:195], v[96:99], v[240:243]
    ds_read_b64_tr_b16 v[228:229], v18 offset:24576
    ds_read_b64_tr_b16 v[230:231], v18 offset:28672
    ds_read_b64_tr_b16 v[232:233], v19 offset:24576
    v_add_f32 v28, v28, v133
    v_cvt_pk_bf16_f32 v130, v132, v133
    v_add_f32 v21, v21, v134
    s_waitcnt lgkmcnt(15)
    v_mfma_f32_16x16x32_bf16 v[244:247], v[196:199], v[96:99], v[244:247]
    ds_read_b64_tr_b16 v[234:235], v19 offset:28672
    ds_read_b64_tr_b16 v[236:237], v20 offset:24576
    ds_read_b64_tr_b16 v[238:239], v20 offset:28672
    v_add_f32 v28, v28, v135
    v_cvt_pk_bf16_f32 v131, v134, v135
    v_mfma_f32_16x16x32_bf16 v[248:251], v[200:203], v[96:99], v[248:251]
    s_waitcnt vmcnt(7)
    s_add_u32 m0, s100, 32768
    s_mov_b32 s61, 98304
    buffer_load_dwordx4 v5, s[24:27], s61 offen nt lds
    v_pk_fma_f32 v[136:137], v[136:137], s[56:57], v[24:25] op_sel_hi:[1,0,0] neg_lo:[0,0,1] neg_hi:[0,0,1]
    v_pk_fma_f32 v[138:139], v[138:139], s[56:57], v[24:25] op_sel_hi:[1,0,0] neg_lo:[0,0,1] neg_hi:[0,0,1]
    v_pk_fma_f32 v[140:141], v[140:141], s[56:57], v[24:25] op_sel_hi:[1,0,0] neg_lo:[0,0,1] neg_hi:[0,0,1]
    s_waitcnt lgkmcnt(15)
    v_mfma_f32_16x16x32_bf16 v[252:255], v[204:207], v[96:99], v[252:255]
    v_pk_fma_f32 v[142:143], v[142:143], s[56:57], v[24:25] op_sel_hi:[1,0,0] neg_lo:[0,0,1] neg_hi:[0,0,1]
    v_exp_f32 v136, v136
    v_exp_f32 v137, v137
    s_waitcnt vmcnt(7)
    s_barrier
    s_waitcnt lgkmcnt(14)
    v_mfma_f32_16x16x32_bf16 v[32:35], v[208:211], v[100:103], v[32:35]
    v_add_u32 v13, -131072, v13
    v_add_u32 v14, -131072, v14
    v_add_u32 v15, -131072, v15
    v_add_u32 v16, -131072, v16
    v_exp_f32 v138, v138
    v_exp_f32 v139, v139
    s_waitcnt lgkmcnt(12)
    v_mfma_f32_16x16x32_bf16 v[36:39], v[212:215], v[100:103], v[36:39]
    v_add_u32 v17, -131072, v17
    v_add_u32 v18, -131072, v18
    v_add_u32 v19, -131072, v19
    v_add_u32 v20, -131072, v20
    v_exp_f32 v140, v140
    v_exp_f32 v141, v141
    s_waitcnt lgkmcnt(10)
    v_mfma_f32_16x16x32_bf16 v[40:43], v[216:219], v[100:103], v[40:43]
    ds_read_b64_tr_b16 v[176:177], v13 offset:0
    ds_read_b64_tr_b16 v[178:179], v13 offset:4096
    ds_read_b64_tr_b16 v[180:181], v14 offset:0
    ds_read_b64_tr_b16 v[182:183], v14 offset:4096
    v_exp_f32 v142, v142
    v_exp_f32 v143, v143
    v_add_f32 v21, v21, v136
    s_waitcnt lgkmcnt(12)
    v_mfma_f32_16x16x32_bf16 v[44:47], v[220:223], v[100:103], v[44:47]
    ds_read_b64_tr_b16 v[184:185], v15 offset:0
    ds_read_b64_tr_b16 v[186:187], v15 offset:4096
    ds_read_b64_tr_b16 v[188:189], v16 offset:0
    ds_read_b64_tr_b16 v[190:191], v16 offset:4096
    v_add_f32 v28, v28, v137
    v_cvt_pk_bf16_f32 v132, v136, v137
    s_waitcnt lgkmcnt(14)
    v_mfma_f32_16x16x32_bf16 v[240:243], v[224:227], v[100:103], v[240:243]
    ds_read_b64_tr_b16 v[192:193], v17 offset:0
    ds_read_b64_tr_b16 v[194:195], v17 offset:4096
    ds_read_b64_tr_b16 v[196:197], v18 offset:0
    ds_read_b64_tr_b16 v[198:199], v18 offset:4096
    v_add_f32 v21, v21, v138
    v_add_f32 v28, v28, v139
    s_waitcnt lgkmcnt(15)
    v_mfma_f32_16x16x32_bf16 v[244:247], v[228:231], v[100:103], v[244:247]
    ds_read_b64_tr_b16 v[200:201], v19 offset:0
    ds_read_b64_tr_b16 v[202:203], v19 offset:4096
    ds_read_b64_tr_b16 v[204:205], v20 offset:0
    ds_read_b64_tr_b16 v[206:207], v20 offset:4096
    v_cvt_pk_bf16_f32 v133, v138, v139
    v_add_f32 v21, v21, v140
    v_add_f32 v28, v28, v141
    s_waitcnt lgkmcnt(15)
    v_mfma_f32_16x16x32_bf16 v[248:251], v[232:235], v[100:103], v[248:251]
    s_add_u32 m0, s100, 32768
    s_mov_b32 s61, 98304
    buffer_load_dwordx4 v6, s[24:27], s61 offen offset:1024 nt lds
    s_add_u32 m0, s100, 131072
    s_mov_b32 s61, 262144
    buffer_load_dwordx4 v7, s[36:39], s61 offen lds
    s_add_u32 m0, s100, 131072
    s_mov_b32 s61, 262144
    buffer_load_dwordx4 v8, s[36:39], s61 offen offset:1024 lds
    v_cvt_pk_bf16_f32 v134, v140, v141
    v_add_f32 v21, v21, v142
    v_mfma_f32_16x16x32_bf16 v[252:255], v[236:239], v[100:103], v[252:255]
    v_add_f32 v28, v28, v143
    v_cvt_pk_bf16_f32 v135, v142, v143
    v_pk_fma_f32 v[144:145], v[144:145], s[56:57], v[24:25] op_sel_hi:[1,0,0] neg_lo:[0,0,1] neg_hi:[0,0,1]
    s_barrier
    v_pk_mul_f32 v[32:33], v[32:33], v[26:27] op_sel:[0,1] op_sel_hi:[1,1]
    v_pk_mul_f32 v[34:35], v[34:35], v[26:27] op_sel:[0,1] op_sel_hi:[1,1]
    v_pk_mul_f32 v[36:37], v[36:37], v[26:27] op_sel:[0,1] op_sel_hi:[1,1]
    v_pk_mul_f32 v[38:39], v[38:39], v[26:27] op_sel:[0,1] op_sel_hi:[1,1]
    v_pk_mul_f32 v[40:41], v[40:41], v[26:27] op_sel:[0,1] op_sel_hi:[1,1]
    v_pk_mul_f32 v[42:43], v[42:43], v[26:27] op_sel:[0,1] op_sel_hi:[1,1]
    v_pk_mul_f32 v[44:45], v[44:45], v[26:27] op_sel:[0,1] op_sel_hi:[1,1]
    v_pk_mul_f32 v[46:47], v[46:47], v[26:27] op_sel:[0,1] op_sel_hi:[1,1]
    v_pk_mul_f32 v[240:241], v[240:241], v[26:27] op_sel:[0,1] op_sel_hi:[1,1]
    v_pk_mul_f32 v[242:243], v[242:243], v[26:27] op_sel:[0,1] op_sel_hi:[1,1]
    v_pk_mul_f32 v[244:245], v[244:245], v[26:27] op_sel:[0,1] op_sel_hi:[1,1]
    v_pk_mul_f32 v[246:247], v[246:247], v[26:27] op_sel:[0,1] op_sel_hi:[1,1]
    v_pk_mul_f32 v[248:249], v[248:249], v[26:27] op_sel:[0,1] op_sel_hi:[1,1]
    v_pk_mul_f32 v[250:251], v[250:251], v[26:27] op_sel:[0,1] op_sel_hi:[1,1]
    v_pk_mul_f32 v[252:253], v[252:253], v[26:27] op_sel:[0,1] op_sel_hi:[1,1]
    v_pk_mul_f32 v[254:255], v[254:255], v[26:27] op_sel:[0,1] op_sel_hi:[1,1]
    s_waitcnt lgkmcnt(14)
    v_mfma_f32_16x16x32_bf16 v[32:35], v[176:179], v[112:115], v[32:35]
    ds_read_b64_tr_b16 v[208:209], v13 offset:8192
    ds_read_b64_tr_b16 v[210:211], v13 offset:12288
    v_pk_fma_f32 v[146:147], v[146:147], s[56:57], v[24:25] op_sel_hi:[1,0,0] neg_lo:[0,0,1] neg_hi:[0,0,1]
    s_waitcnt lgkmcnt(14)
    v_mfma_f32_16x16x32_bf16 v[36:39], v[180:183], v[112:115], v[36:39]
    ds_read_b64_tr_b16 v[212:213], v14 offset:8192
    ds_read_b64_tr_b16 v[214:215], v14 offset:12288
    ds_read_b64_tr_b16 v[216:217], v15 offset:8192
    v_pk_fma_f32 v[148:149], v[148:149], s[56:57], v[24:25] op_sel_hi:[1,0,0] neg_lo:[0,0,1] neg_hi:[0,0,1]
    v_pk_fma_f32 v[150:151], v[150:151], s[56:57], v[24:25] op_sel_hi:[1,0,0] neg_lo:[0,0,1] neg_hi:[0,0,1]
    s_waitcnt lgkmcnt(15)
    v_mfma_f32_16x16x32_bf16 v[40:43], v[184:187], v[112:115], v[40:43]
    ds_read_b64_tr_b16 v[218:219], v15 offset:12288
    ds_read_b64_tr_b16 v[220:221], v16 offset:8192
    ds_read_b64_tr_b16 v[222:223], v16 offset:12288
    v_exp_f32 v144, v144
    v_exp_f32 v145, v145
    s_waitcnt lgkmcnt(15)
    v_mfma_f32_16x16x32_bf16 v[44:47], v[188:191], v[112:115], v[44:47]
    ds_read_b64_tr_b16 v[224:225], v17 offset:8192
    ds_read_b64_tr_b16 v[226:227], v17 offset:12288
    v_exp_f32 v146, v146
    v_exp_f32 v147, v147
    s_waitcnt lgkmcnt(15)
    v_mfma_f32_16x16x32_bf16 v[240:243], v[192:195], v[112:115], v[240:243]
    ds_read_b64_tr_b16 v[228:229], v18 offset:8192
    ds_read_b64_tr_b16 v[230:231], v18 offset:12288
    ds_read_b64_tr_b16 v[232:233], v19 offset:8192
    v_exp_f32 v148, v148
    v_exp_f32 v149, v149
    s_waitcnt lgkmcnt(15)
    v_mfma_f32_16x16x32_bf16 v[244:247], v[196:199], v[112:115], v[244:247]
    ds_read_b64_tr_b16 v[234:235], v19 offset:12288
    ds_read_b64_tr_b16 v[236:237], v20 offset:8192
    ds_read_b64_tr_b16 v[238:239], v20 offset:12288
    v_exp_f32 v150, v150
    v_exp_f32 v151, v151
    v_mfma_f32_16x16x32_bf16 v[248:251], v[200:203], v[112:115], v[248:251]
    s_waitcnt vmcnt(7)
    s_add_u32 m0, s100, 49152
    s_mov_b32 s61, 114688
    buffer_load_dwordx4 v5, s[24:27], s61 offen nt lds
    s_add_u32 m0, s100, 147456
    s_mov_b32 s61, 327680
    buffer_load_dwordx4 v7, s[36:39], s61 offen lds
    s_add_u32 m0, s100, 147456
    s_mov_b32 s61, 327680
    buffer_load_dwordx4 v8, s[36:39], s61 offen offset:1024 lds
    v_add_f32 v21, v21, v144
    v_add_f32 v28, v28, v145
    s_waitcnt lgkmcnt(15)
    v_mfma_f32_16x16x32_bf16 v[252:255], v[204:207], v[112:115], v[252:255]
    v_cvt_pk_bf16_f32 v144, v144, v145
    v_add_f32 v21, v21, v146
    s_waitcnt vmcnt(9)
    s_barrier
    s_waitcnt lgkmcnt(14)
    v_mfma_f32_16x16x32_bf16 v[32:35], v[208:211], v[116:119], v[32:35]
    ds_read_b64_tr_b16 v[176:177], v13 offset:16384
    ds_read_b64_tr_b16 v[178:179], v13 offset:20480
    v_add_f32 v28, v28, v147
    v_cvt_pk_bf16_f32 v145, v146, v147
    s_waitcnt lgkmcnt(14)
    v_mfma_f32_16x16x32_bf16 v[36:39], v[212:215], v[116:119], v[36:39]
    ds_read_b64_tr_b16 v[180:181], v14 offset:16384
    ds_read_b64_tr_b16 v[182:183], v14 offset:20480
    ds_read_b64_tr_b16 v[184:185], v15 offset:16384
    v_add_f32 v21, v21, v148
    v_add_f32 v28, v28, v149
    s_waitcnt lgkmcnt(15)
    v_mfma_f32_16x16x32_bf16 v[40:43], v[216:219], v[116:119], v[40:43]
    ds_read_b64_tr_b16 v[186:187], v15 offset:20480
    ds_read_b64_tr_b16 v[188:189], v16 offset:16384
    ds_read_b64_tr_b16 v[190:191], v16 offset:20480
    v_cvt_pk_bf16_f32 v146, v148, v149
    v_add_f32 v21, v21, v150
    s_waitcnt lgkmcnt(15)
    v_mfma_f32_16x16x32_bf16 v[44:47], v[220:223], v[116:119], v[44:47]
    ds_read_b64_tr_b16 v[192:193], v17 offset:16384
    ds_read_b64_tr_b16 v[194:195], v17 offset:20480
    v_add_f32 v28, v28, v151
    v_cvt_pk_bf16_f32 v147, v150, v151
    v_pk_fma_f32 v[152:153], v[152:153], s[56:57], v[24:25] op_sel_hi:[1,0,0] neg_lo:[0,0,1] neg_hi:[0,0,1]
    s_waitcnt lgkmcnt(15)
    v_mfma_f32_16x16x32_bf16 v[240:243], v[224:227], v[116:119], v[240:243]
    ds_read_b64_tr_b16 v[196:197], v18 offset:16384
    ds_read_b64_tr_b16 v[198:199], v18 offset:20480
    ds_read_b64_tr_b16 v[200:201], v19 offset:16384
    v_pk_fma_f32 v[154:155], v[154:155], s[56:57], v[24:25] op_sel_hi:[1,0,0] neg_lo:[0,0,1] neg_hi:[0,0,1]
    v_pk_fma_f32 v[156:157], v[156:157], s[56:57], v[24:25] op_sel_hi:[1,0,0] neg_lo:[0,0,1] neg_hi:[0,0,1]
    s_waitcnt lgkmcnt(15)
    v_mfma_f32_16x16x32_bf16 v[244:247], v[228:231], v[116:119], v[244:247]
    ds_read_b64_tr_b16 v[202:203], v19 offset:20480
    ds_read_b64_tr_b16 v[204:205], v20 offset:16384
    ds_read_b64_tr_b16 v[206:207], v20 offset:20480
    v_pk_fma_f32 v[158:159], v[158:159], s[56:57], v[24:25] op_sel_hi:[1,0,0] neg_lo:[0,0,1] neg_hi:[0,0,1]
    v_exp_f32 v152, v152
    v_mfma_f32_16x16x32_bf16 v[248:251], v[232:235], v[116:119], v[248:251]
    s_add_u32 m0, s100, 49152
    s_mov_b32 s61, 114688
    buffer_load_dwordx4 v6, s[24:27], s61 offen offset:1024 nt lds
    v_exp_f32 v153, v153
    v_exp_f32 v154, v154
    s_waitcnt lgkmcnt(15)
    v_mfma_f32_16x16x32_bf16 v[252:255], v[236:239], v[116:119], v[252:255]
    v_exp_f32 v155, v155
    v_exp_f32 v156, v156
    v_exp_f32 v157, v157
    s_waitcnt lgkmcnt(14)
    v_mfma_f32_16x16x32_bf16 v[32:35], v[176:179], v[128:131], v[32:35]
    ds_read_b64_tr_b16 v[208:209], v13 offset:24576
    ds_read_b64_tr_b16 v[210:211], v13 offset:28672
    v_exp_f32 v158, v158
    v_exp_f32 v159, v159
    s_waitcnt lgkmcnt(14)
    v_mfma_f32_16x16x32_bf16 v[36:39], v[180:183], v[128:131], v[36:39]
    ds_read_b64_tr_b16 v[212:213], v14 offset:24576
    ds_read_b64_tr_b16 v[214:215], v14 offset:28672
    ds_read_b64_tr_b16 v[216:217], v15 offset:24576
    v_add_f32 v21, v21, v152
    v_add_f32 v28, v28, v153
    v_cvt_pk_bf16_f32 v148, v152, v153
    s_waitcnt lgkmcnt(15)
    v_mfma_f32_16x16x32_bf16 v[40:43], v[184:187], v[128:131], v[40:43]
    ds_read_b64_tr_b16 v[218:219], v15 offset:28672
    ds_read_b64_tr_b16 v[220:221], v16 offset:24576
    ds_read_b64_tr_b16 v[222:223], v16 offset:28672
    v_add_f32 v21, v21, v154
    v_add_f32 v28, v28, v155
    s_waitcnt lgkmcnt(15)
    v_mfma_f32_16x16x32_bf16 v[44:47], v[188:191], v[128:131], v[44:47]
    ds_read_b64_tr_b16 v[224:225], v17 offset:24576
    ds_read_b64_tr_b16 v[226:227], v17 offset:28672
    v_cvt_pk_bf16_f32 v149, v154, v155
    v_add_f32 v21, v21, v156
    v_add_f32 v28, v28, v157
    s_waitcnt lgkmcnt(15)
    v_mfma_f32_16x16x32_bf16 v[240:243], v[192:195], v[128:131], v[240:243]
    ds_read_b64_tr_b16 v[228:229], v18 offset:24576
    ds_read_b64_tr_b16 v[230:231], v18 offset:28672
    ds_read_b64_tr_b16 v[232:233], v19 offset:24576
    v_cvt_pk_bf16_f32 v150, v156, v157
    v_add_f32 v21, v21, v158
    v_add_f32 v28, v28, v159
    s_waitcnt lgkmcnt(15)
    v_mfma_f32_16x16x32_bf16 v[244:247], v[196:199], v[128:131], v[244:247]
    ds_read_b64_tr_b16 v[234:235], v19 offset:28672
    ds_read_b64_tr_b16 v[236:237], v20 offset:24576
    ds_read_b64_tr_b16 v[238:239], v20 offset:28672
    v_cvt_pk_bf16_f32 v151, v158, v159
    v_pk_fma_f32 v[160:161], v[160:161], s[56:57], v[24:25] op_sel_hi:[1,0,0] neg_lo:[0,0,1] neg_hi:[0,0,1]
    v_mfma_f32_16x16x32_bf16 v[248:251], v[200:203], v[128:131], v[248:251]
    v_pk_fma_f32 v[162:163], v[162:163], s[56:57], v[24:25] op_sel_hi:[1,0,0] neg_lo:[0,0,1] neg_hi:[0,0,1]
    v_pk_fma_f32 v[164:165], v[164:165], s[56:57], v[24:25] op_sel_hi:[1,0,0] neg_lo:[0,0,1] neg_hi:[0,0,1]
    v_pk_fma_f32 v[166:167], v[166:167], s[56:57], v[24:25] op_sel_hi:[1,0,0] neg_lo:[0,0,1] neg_hi:[0,0,1]
    s_waitcnt lgkmcnt(15)
    v_mfma_f32_16x16x32_bf16 v[252:255], v[204:207], v[128:131], v[252:255]
    v_exp_f32 v160, v160
    v_exp_f32 v161, v161
    v_exp_f32 v162, v162
    s_waitcnt vmcnt(6)
    s_barrier
    s_waitcnt lgkmcnt(14)
    v_mfma_f32_16x16x32_bf16 v[32:35], v[208:211], v[132:135], v[32:35]
    ds_read_b64_tr_b16 v[176:177], v13 offset:32768
    ds_read_b64_tr_b16 v[178:179], v13 offset:36864
    v_exp_f32 v163, v163
    v_exp_f32 v164, v164
    s_waitcnt lgkmcnt(14)
    v_mfma_f32_16x16x32_bf16 v[36:39], v[212:215], v[132:135], v[36:39]
    ds_read_b64_tr_b16 v[180:181], v14 offset:32768
    ds_read_b64_tr_b16 v[182:183], v14 offset:36864
    ds_read_b64_tr_b16 v[184:185], v15 offset:32768
    v_exp_f32 v165, v165
    v_exp_f32 v166, v166
    v_exp_f32 v167, v167
    s_waitcnt lgkmcnt(15)
    v_mfma_f32_16x16x32_bf16 v[40:43], v[216:219], v[132:135], v[40:43]
    ds_read_b64_tr_b16 v[186:187], v15 offset:36864
    ds_read_b64_tr_b16 v[188:189], v16 offset:32768
    ds_read_b64_tr_b16 v[190:191], v16 offset:36864
    v_add_f32 v21, v21, v160
    v_add_f32 v28, v28, v161
    s_waitcnt lgkmcnt(15)
    v_mfma_f32_16x16x32_bf16 v[44:47], v[220:223], v[132:135], v[44:47]
    ds_read_b64_tr_b16 v[192:193], v17 offset:32768
    ds_read_b64_tr_b16 v[194:195], v17 offset:36864
    v_cvt_pk_bf16_f32 v160, v160, v161
    v_add_f32 v21, v21, v162
    v_add_f32 v28, v28, v163
    s_waitcnt lgkmcnt(15)
    v_mfma_f32_16x16x32_bf16 v[240:243], v[224:227], v[132:135], v[240:243]
    ds_read_b64_tr_b16 v[196:197], v18 offset:32768
    ds_read_b64_tr_b16 v[198:199], v18 offset:36864
    ds_read_b64_tr_b16 v[200:201], v19 offset:32768
    v_cvt_pk_bf16_f32 v161, v162, v163
    v_add_f32 v21, v21, v164
    s_waitcnt lgkmcnt(15)
    v_mfma_f32_16x16x32_bf16 v[244:247], v[228:231], v[132:135], v[244:247]
    ds_read_b64_tr_b16 v[202:203], v19 offset:36864
    ds_read_b64_tr_b16 v[204:205], v20 offset:32768
    ds_read_b64_tr_b16 v[206:207], v20 offset:36864
    v_add_f32 v28, v28, v165
    v_cvt_pk_bf16_f32 v162, v164, v165
    v_add_f32 v21, v21, v166
    v_mfma_f32_16x16x32_bf16 v[248:251], v[232:235], v[132:135], v[248:251]
    s_add_u32 m0, s100, 0
    s_mov_b32 s61, 393216
    buffer_load_dwordx4 v7, s[36:39], s61 offen lds
    s_add_u32 m0, s100, 0
    s_mov_b32 s61, 393216
    buffer_load_dwordx4 v8, s[36:39], s61 offen offset:1024 lds
    v_add_f32 v28, v28, v167
    v_cvt_pk_bf16_f32 v163, v166, v167
    s_waitcnt lgkmcnt(15)
    v_mfma_f32_16x16x32_bf16 v[252:255], v[236:239], v[132:135], v[252:255]
    v_pk_fma_f32 v[168:169], v[168:169], s[56:57], v[24:25] op_sel_hi:[1,0,0] neg_lo:[0,0,1] neg_hi:[0,0,1]
    v_pk_fma_f32 v[170:171], v[170:171], s[56:57], v[24:25] op_sel_hi:[1,0,0] neg_lo:[0,0,1] neg_hi:[0,0,1]
    v_pk_fma_f32 v[172:173], v[172:173], s[56:57], v[24:25] op_sel_hi:[1,0,0] neg_lo:[0,0,1] neg_hi:[0,0,1]
    s_waitcnt lgkmcnt(14)
    v_mfma_f32_16x16x32_bf16 v[32:35], v[176:179], v[144:147], v[32:35]
    ds_read_b64_tr_b16 v[208:209], v13 offset:40960
    ds_read_b64_tr_b16 v[210:211], v13 offset:45056
    v_pk_fma_f32 v[174:175], v[174:175], s[56:57], v[24:25] op_sel_hi:[1,0,0] neg_lo:[0,0,1] neg_hi:[0,0,1]
    v_exp_f32 v168, v168
    s_waitcnt lgkmcnt(14)
    v_mfma_f32_16x16x32_bf16 v[36:39], v[180:183], v[144:147], v[36:39]
    ds_read_b64_tr_b16 v[212:213], v14 offset:40960
    ds_read_b64_tr_b16 v[214:215], v14 offset:45056
    ds_read_b64_tr_b16 v[216:217], v15 offset:40960
    v_exp_f32 v169, v169
    v_exp_f32 v170, v170
    s_waitcnt lgkmcnt(15)
    v_mfma_f32_16x16x32_bf16 v[40:43], v[184:187], v[144:147], v[40:43]
    ds_read_b64_tr_b16 v[218:219], v15 offset:45056
    ds_read_b64_tr_b16 v[220:221], v16 offset:40960
    ds_read_b64_tr_b16 v[222:223], v16 offset:45056
    v_exp_f32 v171, v171
    v_exp_f32 v172, v172
    s_waitcnt lgkmcnt(15)
    v_mfma_f32_16x16x32_bf16 v[44:47], v[188:191], v[144:147], v[44:47]
    ds_read_b64_tr_b16 v[224:225], v17 offset:40960
    ds_read_b64_tr_b16 v[226:227], v17 offset:45056
    v_exp_f32 v173, v173
    v_exp_f32 v174, v174
    s_waitcnt lgkmcnt(15)
    v_mfma_f32_16x16x32_bf16 v[240:243], v[192:195], v[144:147], v[240:243]
    ds_read_b64_tr_b16 v[228:229], v18 offset:40960
    ds_read_b64_tr_b16 v[230:231], v18 offset:45056
    ds_read_b64_tr_b16 v[232:233], v19 offset:40960
    v_exp_f32 v175, v175
    v_add_f32 v21, v21, v168
    s_waitcnt lgkmcnt(15)
    v_mfma_f32_16x16x32_bf16 v[244:247], v[196:199], v[144:147], v[244:247]
    ds_read_b64_tr_b16 v[234:235], v19 offset:45056
    ds_read_b64_tr_b16 v[236:237], v20 offset:40960
    ds_read_b64_tr_b16 v[238:239], v20 offset:45056
    v_add_f32 v28, v28, v169
    v_cvt_pk_bf16_f32 v164, v168, v169
    v_mfma_f32_16x16x32_bf16 v[248:251], v[200:203], v[144:147], v[248:251]
    v_add_f32 v21, v21, v170
    v_add_f32 v28, v28, v171
    s_waitcnt lgkmcnt(15)
    v_mfma_f32_16x16x32_bf16 v[252:255], v[204:207], v[144:147], v[252:255]
    v_cvt_pk_bf16_f32 v165, v170, v171
    v_add_f32 v21, v21, v172
    s_waitcnt vmcnt(2)
    s_barrier
    s_waitcnt lgkmcnt(14)
    v_mfma_f32_16x16x32_bf16 v[32:35], v[208:211], v[148:151], v[32:35]
    ds_read_b64_tr_b16 v[176:177], v13 offset:49152
    ds_read_b64_tr_b16 v[178:179], v13 offset:53248
    s_waitcnt lgkmcnt(14)
    v_mfma_f32_16x16x32_bf16 v[36:39], v[212:215], v[148:151], v[36:39]
    ds_read_b64_tr_b16 v[180:181], v14 offset:49152
    ds_read_b64_tr_b16 v[182:183], v14 offset:53248
    ds_read_b64_tr_b16 v[184:185], v15 offset:49152
    v_add_f32 v28, v28, v173
    s_waitcnt lgkmcnt(15)
    v_mfma_f32_16x16x32_bf16 v[40:43], v[216:219], v[148:151], v[40:43]
    ds_read_b64_tr_b16 v[186:187], v15 offset:53248
    ds_read_b64_tr_b16 v[188:189], v16 offset:49152
    ds_read_b64_tr_b16 v[190:191], v16 offset:53248
    s_waitcnt lgkmcnt(15)
    v_mfma_f32_16x16x32_bf16 v[44:47], v[220:223], v[148:151], v[44:47]
    ds_read_b64_tr_b16 v[192:193], v17 offset:49152
    ds_read_b64_tr_b16 v[194:195], v17 offset:53248
    v_cvt_pk_bf16_f32 v166, v172, v173
    s_waitcnt lgkmcnt(15)
    v_mfma_f32_16x16x32_bf16 v[240:243], v[224:227], v[148:151], v[240:243]
    ds_read_b64_tr_b16 v[196:197], v18 offset:49152
    ds_read_b64_tr_b16 v[198:199], v18 offset:53248
    ds_read_b64_tr_b16 v[200:201], v19 offset:49152
    v_add_f32 v21, v21, v174
    s_waitcnt lgkmcnt(15)
    v_mfma_f32_16x16x32_bf16 v[244:247], v[228:231], v[148:151], v[244:247]
    ds_read_b64_tr_b16 v[202:203], v19 offset:53248
    ds_read_b64_tr_b16 v[204:205], v20 offset:49152
    ds_read_b64_tr_b16 v[206:207], v20 offset:53248
    v_mfma_f32_16x16x32_bf16 v[248:251], v[232:235], v[148:151], v[248:251]
    s_add_u32 m0, s100, 16384
    s_mov_b32 s61, 458752
    buffer_load_dwordx4 v7, s[36:39], s61 offen lds
    s_add_u32 m0, s100, 16384
    s_mov_b32 s61, 458752
    buffer_load_dwordx4 v8, s[36:39], s61 offen offset:1024 lds
    v_add_f32 v28, v28, v175
    s_waitcnt lgkmcnt(15)
    v_mfma_f32_16x16x32_bf16 v[252:255], v[236:239], v[148:151], v[252:255]
    v_cvt_pk_bf16_f32 v167, v174, v175
    s_waitcnt lgkmcnt(14)
    v_mfma_f32_16x16x32_bf16 v[32:35], v[176:179], v[160:163], v[32:35]
    ds_read_b64_tr_b16 v[208:209], v13 offset:57344
    ds_read_b64_tr_b16 v[210:211], v13 offset:61440
    s_waitcnt lgkmcnt(14)
    v_mfma_f32_16x16x32_bf16 v[36:39], v[180:183], v[160:163], v[36:39]
    ds_read_b64_tr_b16 v[212:213], v14 offset:57344
    ds_read_b64_tr_b16 v[214:215], v14 offset:61440
    ds_read_b64_tr_b16 v[216:217], v15 offset:57344
    s_waitcnt lgkmcnt(15)
    v_mfma_f32_16x16x32_bf16 v[40:43], v[184:187], v[160:163], v[40:43]
    ds_read_b64_tr_b16 v[218:219], v15 offset:61440
    ds_read_b64_tr_b16 v[220:221], v16 offset:57344
    ds_read_b64_tr_b16 v[222:223], v16 offset:61440
    s_waitcnt lgkmcnt(15)
    v_mfma_f32_16x16x32_bf16 v[44:47], v[188:191], v[160:163], v[44:47]
    ds_read_b64_tr_b16 v[224:225], v17 offset:57344
    ds_read_b64_tr_b16 v[226:227], v17 offset:61440
    s_waitcnt lgkmcnt(15)
    v_mfma_f32_16x16x32_bf16 v[240:243], v[192:195], v[160:163], v[240:243]
    ds_read_b64_tr_b16 v[228:229], v18 offset:57344
    ds_read_b64_tr_b16 v[230:231], v18 offset:61440
    ds_read_b64_tr_b16 v[232:233], v19 offset:57344
    s_waitcnt lgkmcnt(15)
    v_mfma_f32_16x16x32_bf16 v[244:247], v[196:199], v[160:163], v[244:247]
    ds_read_b64_tr_b16 v[234:235], v19 offset:61440
    ds_read_b64_tr_b16 v[236:237], v20 offset:57344
    ds_read_b64_tr_b16 v[238:239], v20 offset:61440
    v_mfma_f32_16x16x32_bf16 v[248:251], v[200:203], v[160:163], v[248:251]
    s_waitcnt lgkmcnt(15)
    v_mfma_f32_16x16x32_bf16 v[252:255], v[204:207], v[160:163], v[252:255]
    s_waitcnt lgkmcnt(14)
    v_mfma_f32_16x16x32_bf16 v[32:35], v[208:211], v[164:167], v[32:35]
    s_waitcnt lgkmcnt(12)
    v_mfma_f32_16x16x32_bf16 v[36:39], v[212:215], v[164:167], v[36:39]
    s_waitcnt lgkmcnt(10)
    v_mfma_f32_16x16x32_bf16 v[40:43], v[216:219], v[164:167], v[40:43]
    s_waitcnt lgkmcnt(8)
    v_mfma_f32_16x16x32_bf16 v[44:47], v[220:223], v[164:167], v[44:47]
    s_waitcnt lgkmcnt(6)
    v_mfma_f32_16x16x32_bf16 v[240:243], v[224:227], v[164:167], v[240:243]
    s_waitcnt lgkmcnt(4)
    v_mfma_f32_16x16x32_bf16 v[244:247], v[228:231], v[164:167], v[244:247]
    s_waitcnt lgkmcnt(2)
    v_mfma_f32_16x16x32_bf16 v[248:251], v[232:235], v[164:167], v[248:251]
    s_waitcnt lgkmcnt(0)
    v_mfma_f32_16x16x32_bf16 v[252:255], v[236:239], v[164:167], v[252:255]
    v_add_f32 v21, v21, v28
    v_mov_b32 v23, v21
    s_nop 1
    v_permlane32_swap_b32 v21, v23
    s_nop 0
    v_add_f32 v21, v21, v23
    v_mov_b32 v23, v21
    s_nop 1
    v_permlane16_swap_b32 v21, v23
    s_nop 0
    v_add_f32 v21, v21, v23
    v_log_f32 v160, v21
    v_rcp_f32 v162, v21
    v_add_f32 v160, v160, v24
    s_and_b32 s60, s55, 0xff
    v_pk_mul_f32 v[32:33], v[32:33], v[162:163] op_sel_hi:[1,0]
    v_pk_mul_f32 v[34:35], v[34:35], v[162:163] op_sel_hi:[1,0]
    v_pk_mul_f32 v[36:37], v[36:37], v[162:163] op_sel_hi:[1,0]
    v_pk_mul_f32 v[38:39], v[38:39], v[162:163] op_sel_hi:[1,0]
    v_pk_mul_f32 v[40:41], v[40:41], v[162:163] op_sel_hi:[1,0]
    v_pk_mul_f32 v[42:43], v[42:43], v[162:163] op_sel_hi:[1,0]
    v_pk_mul_f32 v[44:45], v[44:45], v[162:163] op_sel_hi:[1,0]
    v_pk_mul_f32 v[46:47], v[46:47], v[162:163] op_sel_hi:[1,0]
    v_pk_mul_f32 v[240:241], v[240:241], v[162:163] op_sel_hi:[1,0]
    v_pk_mul_f32 v[242:243], v[242:243], v[162:163] op_sel_hi:[1,0]
    v_pk_mul_f32 v[244:245], v[244:245], v[162:163] op_sel_hi:[1,0]
    v_pk_mul_f32 v[246:247], v[246:247], v[162:163] op_sel_hi:[1,0]
    v_pk_mul_f32 v[248:249], v[248:249], v[162:163] op_sel_hi:[1,0]
    v_pk_mul_f32 v[250:251], v[250:251], v[162:163] op_sel_hi:[1,0]
    v_pk_mul_f32 v[252:253], v[252:253], v[162:163] op_sel_hi:[1,0]
    v_pk_mul_f32 v[254:255], v[254:255], v[162:163] op_sel_hi:[1,0]
    v_mov_b32 v23, s8
    v_cvt_pk_bf16_f32 v144, v32, v33
    v_cvt_pk_bf16_f32 v145, v34, v35
    v_cvt_pk_bf16_f32 v146, v36, v37
    v_cvt_pk_bf16_f32 v147, v38, v39
    v_cvt_pk_bf16_f32 v148, v40, v41
    v_cvt_pk_bf16_f32 v149, v42, v43
    v_cvt_pk_bf16_f32 v150, v44, v45
    v_cvt_pk_bf16_f32 v151, v46, v47
    v_cvt_pk_bf16_f32 v152, v240, v241
    v_cvt_pk_bf16_f32 v153, v242, v243
    v_cvt_pk_bf16_f32 v154, v244, v245
    v_cvt_pk_bf16_f32 v155, v246, v247
    v_cvt_pk_bf16_f32 v156, v248, v249
    v_cvt_pk_bf16_f32 v157, v250, v251
    v_cvt_pk_bf16_f32 v158, v252, v253
    v_cvt_pk_bf16_f32 v159, v254, v255
    v_bfi_b32 v144, v23, s4, v144
    v_bfi_b32 v145, v23, s5, v145
    v_bfi_b32 v146, v23, s6, v146
    v_bfi_b32 v147, v23, s7, v147
    v_bfi_b32 v148, v23, s4, v148
    v_bfi_b32 v149, v23, s5, v149
    v_bfi_b32 v150, v23, s6, v150
    v_bfi_b32 v151, v23, s7, v151
    v_bfi_b32 v152, v23, s4, v152
    v_bfi_b32 v153, v23, s5, v153
    v_bfi_b32 v154, v23, s6, v154
    v_bfi_b32 v155, v23, s7, v155
    v_bfi_b32 v156, v23, s4, v156
    v_bfi_b32 v157, v23, s5, v157
    v_bfi_b32 v158, v23, s6, v158
    v_bfi_b32 v159, v23, s7, v159
    v_mov_b32 v164, v160
    v_mov_b32 v165, s55
    v_lshlrev_b32 v161, 3, v1
    s_cmp_eq_u32 s3, 0
    s_cbranch_scc1 L_stg11
    buffer_store_dwordx4 v[144:147], v2, s[40:43], s101 offen offset:0
    buffer_store_dwordx4 v[148:151], v2, s[40:43], s101 offen offset:1024
    buffer_store_dwordx4 v[152:155], v2, s[40:43], s101 offen offset:2048
    buffer_store_dwordx4 v[156:159], v2, s[40:43], s101 offen offset:3072
    s_add_u32 s59, s101, 4096
    s_mov_b64 exec, 0xffff
    buffer_store_dwordx2 v[164:165], v161, s[40:43], s59 offen
    s_mov_b64 exec, -1
    s_branch L_std12
L_stg11:
    buffer_store_dwordx4 v[144:147], v2, s[40:43], s101 offen offset:0 sc1
    buffer_store_dwordx4 v[148:151], v2, s[40:43], s101 offen offset:1024 sc1
    buffer_store_dwordx4 v[152:155], v2, s[40:43], s101 offen offset:2048 sc1
    buffer_store_dwordx4 v[156:159], v2, s[40:43], s101 offen offset:3072 sc1
    s_add_u32 s59, s101, 4096
    s_mov_b64 exec, 0xffff
    buffer_store_dwordx2 v[164:165], v161, s[40:43], s59 offen sc1
    s_mov_b64 exec, -1
L_std12:
    s_barrier
    v_mov_b32 v28, v13
    s_cmp_eq_u32 s53, 1
    s_cselect_b64 vcc, -1, 0
    v_cndmask_b32 v28, v28, v15, vcc
    s_cmp_eq_u32 s53, 2
    s_cselect_b64 vcc, -1, 0
    v_cndmask_b32 v28, v28, v17, vcc
    s_cmp_eq_u32 s53, 3
    s_cselect_b64 vcc, -1, 0
    v_cndmask_b32 v28, v28, v19, vcc
    v_mov_b32 v29, v14
    s_cmp_eq_u32 s53, 1
    s_cselect_b64 vcc, -1, 0
    v_cndmask_b32 v29, v29, v16, vcc
    s_cmp_eq_u32 s53, 2
    s_cselect_b64 vcc, -1, 0
    v_cndmask_b32 v29, v29, v18, vcc
    s_cmp_eq_u32 s53, 3
    s_cselect_b64 vcc, -1, 0
    v_cndmask_b32 v29, v29, v20, vcc
    s_add_u32 s58, s51, 1
    s_and_b32 s58, s58, 3
    s_lshl_b32 s59, s50, 2
    s_add_u32 s58, s58, s59
    s_lshl_b32 s58, s58, 3
    s_add_u32 s58, s58, s49
    s_lshl_b32 s58, s58, 16
    s_lshl_b32 s59, s48, 13
    s_add_u32 s58, s58, s59
    s_add_u32 s62, s58, 8388608
    s_add_u32 s63, s62, 4096
    s_add_u32 s58, s51, 2
    s_and_b32 s58, s58, 3
    s_lshl_b32 s59, s50, 2
    s_add_u32 s58, s58, s59
    s_lshl_b32 s58, s58, 3
    s_add_u32 s58, s58, s49
    s_lshl_b32 s58, s58, 16
    s_lshl_b32 s59, s48, 13
    s_add_u32 s58, s58, s59
    s_add_u32 s64, s58, 8388608
    s_add_u32 s65, s64, 4096
    s_add_u32 s58, s51, 3
    s_and_b32 s58, s58, 3
    s_lshl_b32 s59, s50, 2
    s_add_u32 s58, s58, s59
    s_lshl_b32 s58, s58, 3
    s_add_u32 s58, s58, s49
    s_lshl_b32 s58, s58, 16
    s_lshl_b32 s59, s48, 13
    s_add_u32 s58, s58, s59
    s_add_u32 s66, s58, 8388608
    s_add_u32 s67, s66, 4096
    v_and_b32 v161, 15, v1
    v_lshlrev_b32 v161, 3, v161
    v_add_u32 v28, 65536, v28
    v_add_u32 v29, 65536, v29
    ds_read_b64_tr_b16 v[48:49], v28 offset:0
    ds_read_b64_tr_b16 v[50:51], v28 offset:4096
    ds_read_b64_tr_b16 v[52:53], v29 offset:0
    ds_read_b64_tr_b16 v[54:55], v29 offset:4096
    ds_read_b64_tr_b16 v[56:57], v28 offset:8192
    ds_read_b64_tr_b16 v[58:59], v28 offset:12288
    ds_read_b64_tr_b16 v[60:61], v29 offset:8192
    ds_read_b64_tr_b16 v[62:63], v29 offset:12288
    ds_read_b64_tr_b16 v[64:65], v28 offset:16384
    ds_read_b64_tr_b16 v[66:67], v28 offset:20480
    ds_read_b64_tr_b16 v[68:69], v29 offset:16384
    ds_read_b64_tr_b16 v[70:71], v29 offset:20480
    ds_read_b64_tr_b16 v[72:73], v28 offset:24576
    ds_read_b64_tr_b16 v[74:75], v28 offset:28672
    ds_read_b64_tr_b16 v[76:77], v29 offset:24576
    ds_read_b64_tr_b16 v[78:79], v29 offset:28672
    ds_read_b64_tr_b16 v[112:113], v28 offset:32768
    ds_read_b64_tr_b16 v[114:115], v28 offset:36864
    ds_read_b64_tr_b16 v[116:117], v29 offset:32768
    ds_read_b64_tr_b16 v[118:119], v29 offset:36864
    ds_read_b64_tr_b16 v[120:121], v28 offset:40960
    ds_read_b64_tr_b16 v[122:123], v28 offset:45056
    ds_read_b64_tr_b16 v[124:125], v29 offset:40960
    ds_read_b64_tr_b16 v[126:127], v29 offset:45056
    ds_read_b64_tr_b16 v[128:129], v28 offset:49152
    ds_read_b64_tr_b16 v[130:131], v28 offset:53248
    ds_read_b64_tr_b16 v[132:133], v29 offset:49152
    ds_read_b64_tr_b16 v[134:135], v29 offset:53248
    ds_read_b64_tr_b16 v[136:137], v28 offset:57344
    ds_read_b64_tr_b16 v[138:139], v28 offset:61440
    ds_read_b64_tr_b16 v[140:141], v29 offset:57344
    ds_read_b64_tr_b16 v[142:143], v29 offset:61440
    v_add_u32 v28, 65536, v28
    v_add_u32 v29, 65536, v29
    ds_read_b64_tr_b16 v[192:193], v28 offset:16384
    ds_read_b64_tr_b16 v[194:195], v28 offset:20480
    ds_read_b64_tr_b16 v[196:197], v29 offset:16384
    ds_read_b64_tr_b16 v[198:199], v29 offset:20480
    ds_read_b64_tr_b16 v[200:201], v28 offset:24576
    ds_read_b64_tr_b16 v[202:203], v28 offset:28672
    ds_read_b64_tr_b16 v[204:205], v29 offset:24576
    ds_read_b64_tr_b16 v[206:207], v29 offset:28672
    s_mov_b32 s69, 0
L_poll13:
    buffer_load_dwordx2 v[166:167], v161, s[40:43], s63 offen sc1
    buffer_load_dwordx2 v[168:169], v161, s[40:43], s65 offen sc1
    buffer_load_dwordx2 v[170:171], v161, s[40:43], s67 offen sc1
    buffer_load_dwordx4 v[80:83], v2, s[40:43], s62 offen offset:0 sc1
    buffer_load_dwordx4 v[84:87], v2, s[40:43], s62 offen offset:1024 sc1
    buffer_load_dwordx4 v[88:91], v2, s[40:43], s62 offen offset:2048 sc1
    buffer_load_dwordx4 v[92:95], v2, s[40:43], s62 offen offset:3072 sc1
    buffer_load_dwordx4 v[96:99], v2, s[40:43], s64 offen offset:0 sc1
    buffer_load_dwordx4 v[100:103], v2, s[40:43], s64 offen offset:1024 sc1
    buffer_load_dwordx4 v[104:107], v2, s[40:43], s64 offen offset:2048 sc1
    buffer_load_dwordx4 v[108:111], v2, s[40:43], s64 offen offset:3072 sc1
    buffer_load_dwordx4 v[172:175], v2, s[40:43], s66 offen offset:0 sc1
    buffer_load_dwordx4 v[176:179], v2, s[40:43], s66 offen offset:1024 sc1
    buffer_load_dwordx4 v[180:183], v2, s[40:43], s66 offen offset:2048 sc1
    buffer_load_dwordx4 v[184:187], v2, s[40:43], s66 offen offset:3072 sc1
    s_waitcnt vmcnt(0)
    v_xor_b32 v25, s4, v80
    v_xor_b32 v30, s5, v81
    v_bitop3_b32 v25, v25, v82, s6 bitop3:0xf6
    v_bitop3_b32 v30, v30, v83, s7 bitop3:0xf6
    v_bitop3_b32 v25, v25, v84, s4 bitop3:0xf6
    v_bitop3_b32 v30, v30, v85, s5 bitop3:0xf6
    v_bitop3_b32 v25, v25, v86, s6 bitop3:0xf6
    v_bitop3_b32 v30, v30, v87, s7 bitop3:0xf6
    v_bitop3_b32 v25, v25, v88, s4 bitop3:0xf6
    v_bitop3_b32 v30, v30, v89, s5 bitop3:0xf6
    v_bitop3_b32 v25, v25, v90, s6 bitop3:0xf6
    v_bitop3_b32 v30, v30, v91, s7 bitop3:0xf6
    v_bitop3_b32 v25, v25, v92, s4 bitop3:0xf6
    v_bitop3_b32 v30, v30, v93, s5 bitop3:0xf6
    v_bitop3_b32 v25, v25, v94, s6 bitop3:0xf6
    v_bitop3_b32 v30, v30, v95, s7 bitop3:0xf6
    v_bitop3_b32 v25, v25, v96, s4 bitop3:0xf6
    v_bitop3_b32 v30, v30, v97, s5 bitop3:0xf6
    v_bitop3_b32 v25, v25, v98, s6 bitop3:0xf6
    v_bitop3_b32 v30, v30, v99, s7 bitop3:0xf6
    v_bitop3_b32 v25, v25, v100, s4 bitop3:0xf6
    v_bitop3_b32 v30, v30, v101, s5 bitop3:0xf6
    v_bitop3_b32 v25, v25, v102, s6 bitop3:0xf6
    v_bitop3_b32 v30, v30, v103, s7 bitop3:0xf6
    v_bitop3_b32 v25, v25, v104, s4 bitop3:0xf6
    v_bitop3_b32 v30, v30, v105, s5 bitop3:0xf6
    v_bitop3_b32 v25, v25, v106, s6 bitop3:0xf6
    v_bitop3_b32 v30, v30, v107, s7 bitop3:0xf6
    v_bitop3_b32 v25, v25, v108, s4 bitop3:0xf6
    v_bitop3_b32 v30, v30, v109, s5 bitop3:0xf6
    v_bitop3_b32 v25, v25, v110, s6 bitop3:0xf6
    v_bitop3_b32 v30, v30, v111, s7 bitop3:0xf6
    v_bitop3_b32 v25, v25, v172, s4 bitop3:0xf6
    v_bitop3_b32 v30, v30, v173, s5 bitop3:0xf6
    v_bitop3_b32 v25, v25, v174, s6 bitop3:0xf6
    v_bitop3_b32 v30, v30, v175, s7 bitop3:0xf6
    v_bitop3_b32 v25, v25, v176, s4 bitop3:0xf6
    v_bitop3_b32 v30, v30, v177, s5 bitop3:0xf6
    v_bitop3_b32 v25, v25, v178, s6 bitop3:0xf6
    v_bitop3_b32 v30, v30, v179, s7 bitop3:0xf6
    v_bitop3_b32 v25, v25, v180, s4 bitop3:0xf6
    v_bitop3_b32 v30, v30, v181, s5 bitop3:0xf6
    v_bitop3_b32 v25, v25, v182, s6 bitop3:0xf6
    v_bitop3_b32 v30, v30, v183, s7 bitop3:0xf6
    v_bitop3_b32 v25, v25, v184, s4 bitop3:0xf6
    v_bitop3_b32 v30, v30, v185, s5 bitop3:0xf6
    v_bitop3_b32 v25, v25, v186, s6 bitop3:0xf6
    v_bitop3_b32 v30, v30, v187, s7 bitop3:0xf6
    v_or_b32 v25, v25, v30
    v_and_b32 v25, s8, v25
    v_xor_b32 v30, s55, v167
    v_or_b32 v25, v25, v30
    v_xor_b32 v30, s55, v169
    v_or_b32 v25, v25, v30
    v_xor_b32 v30, s55, v171
    v_or_b32 v25, v25, v30
    v_cmp_ne_u32 vcc, 0, v25
    s_cbranch_vccz L_pollok14
    s_add_u32 s69, s69, 1
    s_cmp_gt_u32 s69, 200000
    s_cbranch_scc1 L_pollok14
    s_sleep 1
    s_branch L_poll13
L_pollok14:
    s_nop 7
    v_max_f32 v23, v160, v166
    v_max3_f32 v23, v23, v168, v170
    v_sub_f32 v4, v160, v23
    v_sub_f32 v5, v166, v23
    v_sub_f32 v6, v168, v23
    v_sub_f32 v7, v170, v23
    v_exp_f32 v4, v4
    v_exp_f32 v5, v5
    v_exp_f32 v6, v6
    v_exp_f32 v7, v7
    v_add_f32 v163, v4, v5
    v_add_f32 v163, v163, v6
    v_add_f32 v163, v163, v7
    v_rcp_f32 v163, v163
    s_nop 0
    v_mul_f32 v4, v4, v163
    v_mul_f32 v5, v5, v163
    v_mul_f32 v6, v6, v163
    v_mul_f32 v7, v7, v163
    v_pk_mul_f32 v[32:33], v[32:33], v[4:5] op_sel_hi:[1,0]
    v_pk_mul_f32 v[34:35], v[34:35], v[4:5] op_sel_hi:[1,0]
    v_pk_mul_f32 v[36:37], v[36:37], v[4:5] op_sel_hi:[1,0]
    v_pk_mul_f32 v[38:39], v[38:39], v[4:5] op_sel_hi:[1,0]
    v_pk_mul_f32 v[40:41], v[40:41], v[4:5] op_sel_hi:[1,0]
    v_pk_mul_f32 v[42:43], v[42:43], v[4:5] op_sel_hi:[1,0]
    v_pk_mul_f32 v[44:45], v[44:45], v[4:5] op_sel_hi:[1,0]
    v_pk_mul_f32 v[46:47], v[46:47], v[4:5] op_sel_hi:[1,0]
    v_pk_mul_f32 v[240:241], v[240:241], v[4:5] op_sel_hi:[1,0]
    v_pk_mul_f32 v[242:243], v[242:243], v[4:5] op_sel_hi:[1,0]
    v_pk_mul_f32 v[244:245], v[244:245], v[4:5] op_sel_hi:[1,0]
    v_pk_mul_f32 v[246:247], v[246:247], v[4:5] op_sel_hi:[1,0]
    v_pk_mul_f32 v[248:249], v[248:249], v[4:5] op_sel_hi:[1,0]
    v_pk_mul_f32 v[250:251], v[250:251], v[4:5] op_sel_hi:[1,0]
    v_pk_mul_f32 v[252:253], v[252:253], v[4:5] op_sel_hi:[1,0]
    v_pk_mul_f32 v[254:255], v[254:255], v[4:5] op_sel_hi:[1,0]
    v_lshlrev_b32 v8, 16, v80
    v_and_b32 v9, s68, v80
    v_pk_fma_f32 v[32:33], v[8:9], v[4:5], v[32:33] op_sel:[0,1,0] op_sel_hi:[1,1,1]
    v_lshlrev_b32 v10, 16, v81
    v_and_b32 v11, s68, v81
    v_pk_fma_f32 v[34:35], v[10:11], v[4:5], v[34:35] op_sel:[0,1,0] op_sel_hi:[1,1,1]
    v_lshlrev_b32 v8, 16, v82
    v_and_b32 v9, s68, v82
    v_pk_fma_f32 v[36:37], v[8:9], v[4:5], v[36:37] op_sel:[0,1,0] op_sel_hi:[1,1,1]
    v_lshlrev_b32 v10, 16, v83
    v_and_b32 v11, s68, v83
    v_pk_fma_f32 v[38:39], v[10:11], v[4:5], v[38:39] op_sel:[0,1,0] op_sel_hi:[1,1,1]
    v_lshlrev_b32 v8, 16, v84
    v_and_b32 v9, s68, v84
    v_pk_fma_f32 v[40:41], v[8:9], v[4:5], v[40:41] op_sel:[0,1,0] op_sel_hi:[1,1,1]
    v_lshlrev_b32 v10, 16, v85
    v_and_b32 v11, s68, v85
    v_pk_fma_f32 v[42:43], v[10:11], v[4:5], v[42:43] op_sel:[0,1,0] op_sel_hi:[1,1,1]
    v_lshlrev_b32 v8, 16, v86
    v_and_b32 v9, s68, v86
    v_pk_fma_f32 v[44:45], v[8:9], v[4:5], v[44:45] op_sel:[0,1,0] op_sel_hi:[1,1,1]
    v_lshlrev_b32 v10, 16, v87
    v_and_b32 v11, s68, v87
    v_pk_fma_f32 v[46:47], v[10:11], v[4:5], v[46:47] op_sel:[0,1,0] op_sel_hi:[1,1,1]
    v_lshlrev_b32 v8, 16, v88
    v_and_b32 v9, s68, v88
    v_pk_fma_f32 v[240:241], v[8:9], v[4:5], v[240:241] op_sel:[0,1,0] op_sel_hi:[1,1,1]
    v_lshlrev_b32 v10, 16, v89
    v_and_b32 v11, s68, v89
    v_pk_fma_f32 v[242:243], v[10:11], v[4:5], v[242:243] op_sel:[0,1,0] op_sel_hi:[1,1,1]
    v_lshlrev_b32 v8, 16, v90
    v_and_b32 v9, s68, v90
    v_pk_fma_f32 v[244:245], v[8:9], v[4:5], v[244:245] op_sel:[0,1,0] op_sel_hi:[1,1,1]
    v_lshlrev_b32 v10, 16, v91
    v_and_b32 v11, s68, v91
    v_pk_fma_f32 v[246:247], v[10:11], v[4:5], v[246:247] op_sel:[0,1,0] op_sel_hi:[1,1,1]
    v_lshlrev_b32 v8, 16, v92
    v_and_b32 v9, s68, v92
    v_pk_fma_f32 v[248:249], v[8:9], v[4:5], v[248:249] op_sel:[0,1,0] op_sel_hi:[1,1,1]
    v_lshlrev_b32 v10, 16, v93
    v_and_b32 v11, s68, v93
    v_pk_fma_f32 v[250:251], v[10:11], v[4:5], v[250:251] op_sel:[0,1,0] op_sel_hi:[1,1,1]
    v_lshlrev_b32 v8, 16, v94
    v_and_b32 v9, s68, v94
    v_pk_fma_f32 v[252:253], v[8:9], v[4:5], v[252:253] op_sel:[0,1,0] op_sel_hi:[1,1,1]
    v_lshlrev_b32 v10, 16, v95
    v_and_b32 v11, s68, v95
    v_pk_fma_f32 v[254:255], v[10:11], v[4:5], v[254:255] op_sel:[0,1,0] op_sel_hi:[1,1,1]
    v_lshlrev_b32 v8, 16, v96
    v_and_b32 v9, s68, v96
    v_pk_fma_f32 v[32:33], v[8:9], v[6:7], v[32:33] op_sel:[0,0,0] op_sel_hi:[1,0,1]
    v_lshlrev_b32 v10, 16, v97
    v_and_b32 v11, s68, v97
    v_pk_fma_f32 v[34:35], v[10:11], v[6:7], v[34:35] op_sel:[0,0,0] op_sel_hi:[1,0,1]
    v_lshlrev_b32 v8, 16, v98
    v_and_b32 v9, s68, v98
    v_pk_fma_f32 v[36:37], v[8:9], v[6:7], v[36:37] op_sel:[0,0,0] op_sel_hi:[1,0,1]
    v_lshlrev_b32 v10, 16, v99
    v_and_b32 v11, s68, v99
    v_pk_fma_f32 v[38:39], v[10:11], v[6:7], v[38:39] op_sel:[0,0,0] op_sel_hi:[1,0,1]
    v_lshlrev_b32 v8, 16, v100
    v_and_b32 v9, s68, v100
    v_pk_fma_f32 v[40:41], v[8:9], v[6:7], v[40:41] op_sel:[0,0,0] op_sel_hi:[1,0,1]
    v_lshlrev_b32 v10, 16, v101
    v_and_b32 v11, s68, v101
    v_pk_fma_f32 v[42:43], v[10:11], v[6:7], v[42:43] op_sel:[0,0,0] op_sel_hi:[1,0,1]
    v_lshlrev_b32 v8, 16, v102
    v_and_b32 v9, s68, v102
    v_pk_fma_f32 v[44:45], v[8:9], v[6:7], v[44:45] op_sel:[0,0,0] op_sel_hi:[1,0,1]
    v_lshlrev_b32 v10, 16, v103
    v_and_b32 v11, s68, v103
    v_pk_fma_f32 v[46:47], v[10:11], v[6:7], v[46:47] op_sel:[0,0,0] op_sel_hi:[1,0,1]
    v_lshlrev_b32 v8, 16, v104
    v_and_b32 v9, s68, v104
    v_pk_fma_f32 v[240:241], v[8:9], v[6:7], v[240:241] op_sel:[0,0,0] op_sel_hi:[1,0,1]
    v_lshlrev_b32 v10, 16, v105
    v_and_b32 v11, s68, v105
    v_pk_fma_f32 v[242:243], v[10:11], v[6:7], v[242:243] op_sel:[0,0,0] op_sel_hi:[1,0,1]
    v_lshlrev_b32 v8, 16, v106
    v_and_b32 v9, s68, v106
    v_pk_fma_f32 v[244:245], v[8:9], v[6:7], v[244:245] op_sel:[0,0,0] op_sel_hi:[1,0,1]
    v_lshlrev_b32 v10, 16, v107
    v_and_b32 v11, s68, v107
    v_pk_fma_f32 v[246:247], v[10:11], v[6:7], v[246:247] op_sel:[0,0,0] op_sel_hi:[1,0,1]
    v_lshlrev_b32 v8, 16, v108
    v_and_b32 v9, s68, v108
    v_pk_fma_f32 v[248:249], v[8:9], v[6:7], v[248:249] op_sel:[0,0,0] op_sel_hi:[1,0,1]
    v_lshlrev_b32 v10, 16, v109
    v_and_b32 v11, s68, v109
    v_pk_fma_f32 v[250:251], v[10:11], v[6:7], v[250:251] op_sel:[0,0,0] op_sel_hi:[1,0,1]
    v_lshlrev_b32 v8, 16, v110
    v_and_b32 v9, s68, v110
    v_pk_fma_f32 v[252:253], v[8:9], v[6:7], v[252:253] op_sel:[0,0,0] op_sel_hi:[1,0,1]
    v_lshlrev_b32 v10, 16, v111
    v_and_b32 v11, s68, v111
    v_pk_fma_f32 v[254:255], v[10:11], v[6:7], v[254:255] op_sel:[0,0,0] op_sel_hi:[1,0,1]
    v_lshlrev_b32 v8, 16, v172
    v_and_b32 v9, s68, v172
    v_pk_fma_f32 v[32:33], v[8:9], v[6:7], v[32:33] op_sel:[0,1,0] op_sel_hi:[1,1,1]
    v_lshlrev_b32 v10, 16, v173
    v_and_b32 v11, s68, v173
    v_pk_fma_f32 v[34:35], v[10:11], v[6:7], v[34:35] op_sel:[0,1,0] op_sel_hi:[1,1,1]
    v_lshlrev_b32 v8, 16, v174
    v_and_b32 v9, s68, v174
    v_pk_fma_f32 v[36:37], v[8:9], v[6:7], v[36:37] op_sel:[0,1,0] op_sel_hi:[1,1,1]
    v_lshlrev_b32 v10, 16, v175
    v_and_b32 v11, s68, v175
    v_pk_fma_f32 v[38:39], v[10:11], v[6:7], v[38:39] op_sel:[0,1,0] op_sel_hi:[1,1,1]
    v_lshlrev_b32 v8, 16, v176
    v_and_b32 v9, s68, v176
    v_pk_fma_f32 v[40:41], v[8:9], v[6:7], v[40:41] op_sel:[0,1,0] op_sel_hi:[1,1,1]
    v_lshlrev_b32 v10, 16, v177
    v_and_b32 v11, s68, v177
    v_pk_fma_f32 v[42:43], v[10:11], v[6:7], v[42:43] op_sel:[0,1,0] op_sel_hi:[1,1,1]
    v_lshlrev_b32 v8, 16, v178
    v_and_b32 v9, s68, v178
    v_pk_fma_f32 v[44:45], v[8:9], v[6:7], v[44:45] op_sel:[0,1,0] op_sel_hi:[1,1,1]
    v_lshlrev_b32 v10, 16, v179
    v_and_b32 v11, s68, v179
    v_pk_fma_f32 v[46:47], v[10:11], v[6:7], v[46:47] op_sel:[0,1,0] op_sel_hi:[1,1,1]
    v_lshlrev_b32 v8, 16, v180
    v_and_b32 v9, s68, v180
    v_pk_fma_f32 v[240:241], v[8:9], v[6:7], v[240:241] op_sel:[0,1,0] op_sel_hi:[1,1,1]
    v_lshlrev_b32 v10, 16, v181
    v_and_b32 v11, s68, v181
    v_pk_fma_f32 v[242:243], v[10:11], v[6:7], v[242:243] op_sel:[0,1,0] op_sel_hi:[1,1,1]
    v_lshlrev_b32 v8, 16, v182
    v_and_b32 v9, s68, v182
    v_pk_fma_f32 v[244:245], v[8:9], v[6:7], v[244:245] op_sel:[0,1,0] op_sel_hi:[1,1,1]
    v_lshlrev_b32 v10, 16, v183
    v_and_b32 v11, s68, v183
    v_pk_fma_f32 v[246:247], v[10:11], v[6:7], v[246:247] op_sel:[0,1,0] op_sel_hi:[1,1,1]
    v_lshlrev_b32 v8, 16, v184
    v_and_b32 v9, s68, v184
    v_pk_fma_f32 v[248:249], v[8:9], v[6:7], v[248:249] op_sel:[0,1,0] op_sel_hi:[1,1,1]
    v_lshlrev_b32 v10, 16, v185
    v_and_b32 v11, s68, v185
    v_pk_fma_f32 v[250:251], v[10:11], v[6:7], v[250:251] op_sel:[0,1,0] op_sel_hi:[1,1,1]
    v_lshlrev_b32 v8, 16, v186
    v_and_b32 v9, s68, v186
    v_pk_fma_f32 v[252:253], v[8:9], v[6:7], v[252:253] op_sel:[0,1,0] op_sel_hi:[1,1,1]
    v_lshlrev_b32 v10, 16, v187
    v_and_b32 v11, s68, v187
    v_pk_fma_f32 v[254:255], v[10:11], v[6:7], v[254:255] op_sel:[0,1,0] op_sel_hi:[1,1,1]
    v_cvt_pk_bf16_f32 v144, v32, v33
    v_cvt_pk_bf16_f32 v145, v34, v35
    v_cvt_pk_bf16_f32 v146, v36, v37
    v_cvt_pk_bf16_f32 v147, v38, v39
    v_cvt_pk_bf16_f32 v148, v40, v41
    v_cvt_pk_bf16_f32 v149, v42, v43
    v_cvt_pk_bf16_f32 v150, v44, v45
    v_cvt_pk_bf16_f32 v151, v46, v47
    v_cvt_pk_bf16_f32 v152, v240, v241
    v_cvt_pk_bf16_f32 v153, v242, v243
    v_cvt_pk_bf16_f32 v154, v244, v245
    v_cvt_pk_bf16_f32 v155, v246, v247
    v_cvt_pk_bf16_f32 v156, v248, v249
    v_cvt_pk_bf16_f32 v157, v250, v251
    v_cvt_pk_bf16_f32 v158, v252, v253
    v_cvt_pk_bf16_f32 v159, v254, v255
L_aft15:
    s_nop 7
    s_lshl_b32 s58, s48, 12
    s_add_u32 s58, s58, 32768
    v_add_u32 v23, s58, v2
    ds_write_b128 v23, v[144:147] offset:0
    ds_write_b128 v23, v[148:151] offset:1024
    ds_write_b128 v23, v[152:155] offset:2048
    ds_write_b128 v23, v[156:159] offset:3072
    s_waitcnt vmcnt(0) lgkmcnt(0)
    s_barrier
    s_lshl_b32 s58, s54, 12
    s_add_u32 s58, s58, 32768
    v_add_u32 v23, s58, v2
    ds_read_b128 v[80:83], v23 offset:0
    ds_read_b128 v[84:87], v23 offset:1024
    ds_read_b128 v[88:91], v23 offset:2048
    ds_read_b128 v[92:95], v23 offset:3072
    ds_read_b128 v[96:99], v23 offset:8192
    ds_read_b128 v[100:103], v23 offset:9216
    ds_read_b128 v[104:107], v23 offset:10240
    ds_read_b128 v[108:111], v23 offset:11264
    s_waitcnt lgkmcnt(7)
    v_mfma_f32_16x16x32_bf16 v[240:243], v[48:51], v[80:83], 0
    v_add_u32 v28, -131072, v28
    v_add_u32 v29, -131072, v29
    ds_read_b64_tr_b16 v[208:209], v28 offset:0
    v_mfma_f32_16x16x32_bf16 v[244:247], v[52:55], v[80:83], 0
    ds_read_b64_tr_b16 v[210:211], v28 offset:4096
    ds_read_b64_tr_b16 v[212:213], v29 offset:0
    ds_read_b64_tr_b16 v[214:215], v29 offset:4096
    s_waitcnt lgkmcnt(10)
    v_mfma_f32_16x16x32_bf16 v[240:243], v[56:59], v[84:87], v[240:243]
    ds_read_b64_tr_b16 v[216:217], v28 offset:8192
    ds_read_b64_tr_b16 v[218:219], v28 offset:12288
    ds_read_b64_tr_b16 v[220:221], v29 offset:8192
    v_mfma_f32_16x16x32_bf16 v[244:247], v[60:63], v[84:87], v[244:247]
    ds_read_b64_tr_b16 v[222:223], v29 offset:12288
    ds_read_b64_tr_b16 v[224:225], v28 offset:16384
    ds_read_b64_tr_b16 v[226:227], v28 offset:20480
    s_waitcnt lgkmcnt(15)
    v_mfma_f32_16x16x32_bf16 v[240:243], v[64:67], v[88:91], v[240:243]
    ds_read_b64_tr_b16 v[228:229], v29 offset:16384
    ds_read_b64_tr_b16 v[230:231], v29 offset:20480
    ds_read_b64_tr_b16 v[232:233], v28 offset:24576
    v_mfma_f32_16x16x32_bf16 v[244:247], v[68:71], v[88:91], v[244:247]
    ds_read_b64_tr_b16 v[234:235], v28 offset:28672
    ds_read_b64_tr_b16 v[236:237], v29 offset:24576
    ds_read_b64_tr_b16 v[238:239], v29 offset:28672
    s_waitcnt lgkmcnt(15)
    v_mfma_f32_16x16x32_bf16 v[240:243], v[72:75], v[92:95], v[240:243]
    v_add_u32 v28, 131072, v28
    v_add_u32 v29, 131072, v29
    ds_read_b64_tr_b16 v[176:177], v28 offset:0
    v_mfma_f32_16x16x32_bf16 v[244:247], v[76:79], v[92:95], v[244:247]
    ds_read_b64_tr_b16 v[178:179], v28 offset:4096
    ds_read_b64_tr_b16 v[180:181], v29 offset:0
    ds_read_b64_tr_b16 v[182:183], v29 offset:4096
    v_mfma_f32_16x16x32_bf16 v[240:243], v[112:115], v[96:99], v[240:243]
    ds_read_b64_tr_b16 v[184:185], v28 offset:8192
    ds_read_b64_tr_b16 v[186:187], v28 offset:12288
    ds_read_b64_tr_b16 v[188:189], v29 offset:8192
    v_mfma_f32_16x16x32_bf16 v[244:247], v[116:119], v[96:99], v[244:247]
    ds_read_b64_tr_b16 v[190:191], v29 offset:12288
    ds_read_b128 v[144:147], v23 offset:16384
    ds_read_b128 v[148:151], v23 offset:17408
    v_mfma_f32_16x16x32_bf16 v[240:243], v[120:123], v[100:103], v[240:243]
    ds_read_b128 v[152:155], v23 offset:18432
    ds_read_b128 v[156:159], v23 offset:19456
    ds_read_b128 v[160:163], v23 offset:24576
    v_mfma_f32_16x16x32_bf16 v[244:247], v[124:127], v[100:103], v[244:247]
    ds_read_b128 v[164:167], v23 offset:25600
    ds_read_b128 v[168:171], v23 offset:26624
    ds_read_b128 v[172:175], v23 offset:27648
    v_mfma_f32_16x16x32_bf16 v[240:243], v[128:131], v[104:107], v[240:243]
    v_mfma_f32_16x16x32_bf16 v[244:247], v[132:135], v[104:107], v[244:247]
    v_mfma_f32_16x16x32_bf16 v[240:243], v[136:139], v[108:111], v[240:243]
    v_mfma_f32_16x16x32_bf16 v[244:247], v[140:143], v[108:111], v[244:247]
    s_waitcnt lgkmcnt(0)
    v_mfma_f32_16x16x32_bf16 v[240:243], v[176:179], v[144:147], v[240:243]
    v_mfma_f32_16x16x32_bf16 v[244:247], v[180:183], v[144:147], v[244:247]
    v_mfma_f32_16x16x32_bf16 v[240:243], v[184:187], v[148:151], v[240:243]
    v_mfma_f32_16x16x32_bf16 v[244:247], v[188:191], v[148:151], v[244:247]
    v_mfma_f32_16x16x32_bf16 v[240:243], v[192:195], v[152:155], v[240:243]
    v_mfma_f32_16x16x32_bf16 v[244:247], v[196:199], v[152:155], v[244:247]
    v_mfma_f32_16x16x32_bf16 v[240:243], v[200:203], v[156:159], v[240:243]
    v_mfma_f32_16x16x32_bf16 v[244:247], v[204:207], v[156:159], v[244:247]
    v_mfma_f32_16x16x32_bf16 v[240:243], v[208:211], v[160:163], v[240:243]
    v_mfma_f32_16x16x32_bf16 v[244:247], v[212:215], v[160:163], v[244:247]
    v_mfma_f32_16x16x32_bf16 v[240:243], v[216:219], v[164:167], v[240:243]
    v_mfma_f32_16x16x32_bf16 v[244:247], v[220:223], v[164:167], v[244:247]
    v_mfma_f32_16x16x32_bf16 v[240:243], v[224:227], v[168:171], v[240:243]
    v_mfma_f32_16x16x32_bf16 v[244:247], v[228:231], v[168:171], v[244:247]
    v_mfma_f32_16x16x32_bf16 v[240:243], v[232:235], v[172:175], v[240:243]
    v_mfma_f32_16x16x32_bf16 v[244:247], v[236:239], v[172:175], v[244:247]
    s_lshl_b32 s58, s70, 14
    s_add_u32 s58, s58, s100
    s_add_u32 s58, s58, 29360128
    v_mov_b32 v23, s8
    s_nop 2
    v_cvt_pk_bf16_f32 v48, v240, v241
    v_cvt_pk_bf16_f32 v49, v242, v243
    v_cvt_pk_bf16_f32 v50, v244, v245
    v_cvt_pk_bf16_f32 v51, v246, v247
    v_bfi_b32 v48, v23, s4, v48
    v_bfi_b32 v49, v23, s5, v49
    v_bfi_b32 v50, v23, s6, v50
    v_bfi_b32 v51, v23, s7, v51
    buffer_store_dwordx4 v[48:51], v2, s[40:43], s58 offen sc1
    s_cmp_ge_u32 s48, 2
    s_cbranch_scc1 L_fin
    s_lshl_b32 s58, s50, 2
    s_add_u32 s58, s58, s51
    s_lshl_b32 s58, s58, 17
    s_lshl_b32 s59, s49, 11
    s_add_u32 s58, s58, s59
    s_add_u32 s58, s58, 29360128
    s_mov_b32 s69, 0
L_poll16:
    s_add_u32 s59, s58, 0
    buffer_load_dwordx4 v[56:59], v2, s[40:43], s59 offen sc1
    s_add_u32 s59, s58, 16384
    buffer_load_dwordx4 v[60:63], v2, s[40:43], s59 offen sc1
    s_add_u32 s59, s58, 32768
    buffer_load_dwordx4 v[64:67], v2, s[40:43], s59 offen sc1
    s_add_u32 s59, s58, 49152
    buffer_load_dwordx4 v[68:71], v2, s[40:43], s59 offen sc1
    s_add_u32 s59, s58, 65536
    buffer_load_dwordx4 v[72:75], v2, s[40:43], s59 offen sc1
    s_add_u32 s59, s58, 81920
    buffer_load_dwordx4 v[76:79], v2, s[40:43], s59 offen sc1
    s_add_u32 s59, s58, 98304
    buffer_load_dwordx4 v[80:83], v2, s[40:43], s59 offen sc1
    s_add_u32 s59, s58, 114688
    buffer_load_dwordx4 v[84:87], v2, s[40:43], s59 offen sc1
    s_waitcnt vmcnt(0)
    v_xor_b32 v25, s4, v56
    v_xor_b32 v30, s5, v57
    v_bitop3_b32 v25, v25, v58, s6 bitop3:0xf6
    v_bitop3_b32 v30, v30, v59, s7 bitop3:0xf6
    v_bitop3_b32 v25, v25, v60, s4 bitop3:0xf6
    v_bitop3_b32 v30, v30, v61, s5 bitop3:0xf6
    v_bitop3_b32 v25, v25, v62, s6 bitop3:0xf6
    v_bitop3_b32 v30, v30, v63, s7 bitop3:0xf6
    v_bitop3_b32 v25, v25, v64, s4 bitop3:0xf6
    v_bitop3_b32 v30, v30, v65, s5 bitop3:0xf6
    v_bitop3_b32 v25, v25, v66, s6 bitop3:0xf6
    v_bitop3_b32 v30, v30, v67, s7 bitop3:0xf6
    v_bitop3_b32 v25, v25, v68, s4 bitop3:0xf6
    v_bitop3_b32 v30, v30, v69, s5 bitop3:0xf6
    v_bitop3_b32 v25, v25, v70, s6 bitop3:0xf6
    v_bitop3_b32 v30, v30, v71, s7 bitop3:0xf6
    v_bitop3_b32 v25, v25, v72, s4 bitop3:0xf6
    v_bitop3_b32 v30, v30, v73, s5 bitop3:0xf6
    v_bitop3_b32 v25, v25, v74, s6 bitop3:0xf6
    v_bitop3_b32 v30, v30, v75, s7 bitop3:0xf6
    v_bitop3_b32 v25, v25, v76, s4 bitop3:0xf6
    v_bitop3_b32 v30, v30, v77, s5 bitop3:0xf6
    v_bitop3_b32 v25, v25, v78, s6 bitop3:0xf6
    v_bitop3_b32 v30, v30, v79, s7 bitop3:0xf6
    v_bitop3_b32 v25, v25, v80, s4 bitop3:0xf6
    v_bitop3_b32 v30, v30, v81, s5 bitop3:0xf6
    v_bitop3_b32 v25, v25, v82, s6 bitop3:0xf6
    v_bitop3_b32 v30, v30, v83, s7 bitop3:0xf6
    v_bitop3_b32 v25, v25, v84, s4 bitop3:0xf6
    v_bitop3_b32 v30, v30, v85, s5 bitop3:0xf6
    v_bitop3_b32 v25, v25, v86, s6 bitop3:0xf6
    v_bitop3_b32 v30, v30, v87, s7 bitop3:0xf6
    v_or_b32 v25, v25, v30
    v_and_b32 v25, s8, v25
    v_cmp_ne_u32 vcc, 0, v25
    s_cbranch_vccz L_pollok17
    s_add_u32 s69, s69, 1
    s_cmp_gt_u32 s69, 200000
    s_cbranch_scc1 L_pollok17
    s_sleep 1
    s_branch L_poll16
L_pollok17:
    s_nop 7
    s_cmp_eq_u32 s48, 1
    s_cbranch_scc1 L_z118
    v_lshlrev_b32 v92, 16, v56
    v_and_b32 v93, s68, v56
    v_lshlrev_b32 v94, 16, v57
    v_and_b32 v95, s68, v57
    v_lshlrev_b32 v25, 16, v60
    v_and_b32 v30, s68, v60
    v_add_f32 v92, v92, v25
    v_add_f32 v93, v93, v30
    v_lshlrev_b32 v25, 16, v61
    v_and_b32 v30, s68, v61
    v_add_f32 v94, v94, v25
    v_add_f32 v95, v95, v30
    v_lshlrev_b32 v25, 16, v64
    v_and_b32 v30, s68, v64
    v_add_f32 v92, v92, v25
    v_add_f32 v93, v93, v30
    v_lshlrev_b32 v25, 16, v65
    v_and_b32 v30, s68, v65
    v_add_f32 v94, v94, v25
    v_add_f32 v95, v95, v30
    v_lshlrev_b32 v25, 16, v68
    v_and_b32 v30, s68, v68
    v_add_f32 v92, v92, v25
    v_add_f32 v93, v93, v30
    v_lshlrev_b32 v25, 16, v69
    v_and_b32 v30, s68, v69
    v_add_f32 v94, v94, v25
    v_add_f32 v95, v95, v30
    v_lshlrev_b32 v25, 16, v72
    v_and_b32 v30, s68, v72
    v_add_f32 v92, v92, v25
    v_add_f32 v93, v93, v30
    v_lshlrev_b32 v25, 16, v73
    v_and_b32 v30, s68, v73
    v_add_f32 v94, v94, v25
    v_add_f32 v95, v95, v30
    v_lshlrev_b32 v25, 16, v76
    v_and_b32 v30, s68, v76
    v_add_f32 v92, v92, v25
    v_add_f32 v93, v93, v30
    v_lshlrev_b32 v25, 16, v77
    v_and_b32 v30, s68, v77
    v_add_f32 v94, v94, v25
    v_add_f32 v95, v95, v30
    v_lshlrev_b32 v25, 16, v80
    v_and_b32 v30, s68, v80
    v_add_f32 v92, v92, v25
    v_add_f32 v93, v93, v30
    v_lshlrev_b32 v25, 16, v81
    v_and_b32 v30, s68, v81
    v_add_f32 v94, v94, v25
    v_add_f32 v95, v95, v30
    v_lshlrev_b32 v25, 16, v84
    v_and_b32 v30, s68, v84
    v_add_f32 v92, v92, v25
    v_add_f32 v93, v93, v30
    v_lshlrev_b32 v25, 16, v85
    v_and_b32 v30, s68, v85
    v_add_f32 v94, v94, v25
    v_add_f32 v95, v95, v30
    s_branch L_z219
L_z118:
    v_lshlrev_b32 v92, 16, v58
    v_and_b32 v93, s68, v58
    v_lshlrev_b32 v94, 16, v59
    v_and_b32 v95, s68, v59
    v_lshlrev_b32 v25, 16, v62
    v_and_b32 v30, s68, v62
    v_add_f32 v92, v92, v25
    v_add_f32 v93, v93, v30
    v_lshlrev_b32 v25, 16, v63
    v_and_b32 v30, s68, v63
    v_add_f32 v94, v94, v25
    v_add_f32 v95, v95, v30
    v_lshlrev_b32 v25, 16, v66
    v_and_b32 v30, s68, v66
    v_add_f32 v92, v92, v25
    v_add_f32 v93, v93, v30
    v_lshlrev_b32 v25, 16, v67
    v_and_b32 v30, s68, v67
    v_add_f32 v94, v94, v25
    v_add_f32 v95, v95, v30
    v_lshlrev_b32 v25, 16, v70
    v_and_b32 v30, s68, v70
    v_add_f32 v92, v92, v25
    v_add_f32 v93, v93, v30
    v_lshlrev_b32 v25, 16, v71
    v_and_b32 v30, s68, v71
    v_add_f32 v94, v94, v25
    v_add_f32 v95, v95, v30
    v_lshlrev_b32 v25, 16, v74
    v_and_b32 v30, s68, v74
    v_add_f32 v92, v92, v25
    v_add_f32 v93, v93, v30
    v_lshlrev_b32 v25, 16, v75
    v_and_b32 v30, s68, v75
    v_add_f32 v94, v94, v25
    v_add_f32 v95, v95, v30
    v_lshlrev_b32 v25, 16, v78
    v_and_b32 v30, s68, v78
    v_add_f32 v92, v92, v25
    v_add_f32 v93, v93, v30
    v_lshlrev_b32 v25, 16, v79
    v_and_b32 v30, s68, v79
    v_add_f32 v94, v94, v25
    v_add_f32 v95, v95, v30
    v_lshlrev_b32 v25, 16, v82
    v_and_b32 v30, s68, v82
    v_add_f32 v92, v92, v25
    v_add_f32 v93, v93, v30
    v_lshlrev_b32 v25, 16, v83
    v_and_b32 v30, s68, v83
    v_add_f32 v94, v94, v25
    v_add_f32 v95, v95, v30
    v_lshlrev_b32 v25, 16, v86
    v_and_b32 v30, s68, v86
    v_add_f32 v92, v92, v25
    v_add_f32 v93, v93, v30
    v_lshlrev_b32 v25, 16, v87
    v_and_b32 v30, s68, v87
    v_add_f32 v94, v94, v25
    v_add_f32 v95, v95, v30
L_z219:
    v_cvt_pk_bf16_f32 v96, v92, v93
    v_cvt_pk_bf16_f32 v97, v94, v95
    s_lshl_b32 s58, s50, 15
    s_and_b32 s59, s49, 1
    s_lshl_b32 s59, s59, 14
    s_add_u32 s58, s58, s59
    s_lshl_b32 s59, s51, 8
    s_add_u32 s58, s58, s59
    s_lshr_b32 s59, s49, 1
    s_lshl_b32 s59, s59, 6
    s_add_u32 s58, s58, s59
    s_lshl_b32 s59, s48, 5
    s_add_u32 s58, s58, s59
    buffer_store_dwordx2 v[96:97], v31, s[44:47], s58 offen
    s_and_b32 s58, s70, 0x3f
    s_or_b32 s58, s58, s48
    s_cmp_lg_u32 s58, 0
    s_cbranch_scc1 L_fin
    s_lshl_b32 s58, s52, 7
    v_mov_b32 v23, s55
    v_mov_b32 v25, 0
    s_mov_b64 exec, 1
    buffer_store_dword v23, v25, s[40:43], s58 offen sc1
    s_mov_b64 exec, -1
L_fin:
L_end:
    s_endpgm
L_code_end:
.section .rodata,"a"
.p2align 6
.amdhsa_kernel standalone__gqa_block_cached__near_ridge_kernel
  .amdhsa_next_free_vgpr 256
  .amdhsa_next_free_sgpr 102
  .amdhsa_accum_offset 256
  .amdhsa_group_segment_fixed_size 0
  .amdhsa_kernarg_size 64
  .amdhsa_user_sgpr_count 2
  .amdhsa_user_sgpr_kernarg_segment_ptr 1
  .amdhsa_system_sgpr_workgroup_id_x 1
  .amdhsa_float_denorm_mode_32 3
  .amdhsa_float_denorm_mode_16_64 3
.end_amdhsa_kernel
```
